```python
import torch

def _softmax(x, axis=-1):
    return torch.softmax(x, dim=axis)
def _gelu(x):
    return torch.nn.functional.gelu(x, approximate="tanh")
def _silu(x):
    return torch.nn.functional.silu(x)
def _sigmoid(x):
    return torch.sigmoid(x)
def _layernorm(x, axis=-1, eps=1e-5):
    m = x.mean(dim=axis, keepdim=True)
    v = x.var(dim=axis, keepdim=True, unbiased=False)
    return (x - m) / torch.sqrt(v + eps)
def _scatter_add(tgt, idx, src, axis=0):
    return tgt.clone().index_add_(axis, idx, src)
def _segment_sum(src, seg, n):
    out = torch.zeros((n,) + src.shape[1:], dtype=src.dtype)
    return out.index_add_(0, seg, src)
def _pad(x, pw):
    flat = tuple(v for pair in reversed(pw) for v in pair)
    return torch.nn.functional.pad(x, flat)

kernel_name = 'sequential_preLN__gqa_block_cached__mixer_token_mlp__decode'

def setup_inputs():

    _w = (lambda a: (lambda t: t.to(torch.bfloat16) if t.is_floating_point() else t)(torch.as_tensor(a)))
    def _A_setup():
        B, Sq, D = 2, 1, 640
        Hq, Hkv, Sk, Dh = 32, 32, 8192, 192
        assert Hq % Hkv == 0, (Hq, Hkv)
        return {
            "x": _w((lambda *s: torch.randn(*s, dtype=torch.bfloat16) * 0.05)(B, Sq, D)),
            "k_cache": _w((lambda *s: torch.randn(*s, dtype=torch.bfloat16) * 1.6)(B, Hkv, Sk, Dh)),
            "v_cache": _w((lambda *s: torch.randn(*s, dtype=torch.bfloat16) * 0.8)(B, Hkv, Sk, Dh)),
            "wq": _w((lambda *s: torch.randn(*s, dtype=torch.bfloat16) * 1.6)(D, Hq * Dh) * (D ** -0.5)),
            "wo": _w((lambda *s: torch.randn(*s, dtype=torch.bfloat16) * 0.8)(Hq * Dh, D) * ((Hq * Dh) ** -0.5)),
        }
    _A_in = _A_setup()

    def _B_setup():
        B, S, D, F = 2, 1, 640, 1536
        return {
            "x": _w((lambda *s: torch.randn(*s, dtype=torch.bfloat16) * 0.05)(B, S, D)),
            "w1": _w((lambda *s: torch.randn(*s, dtype=torch.bfloat16) * 1.6)(S, F) * (S ** -0.5)),
            "b1": _w((lambda *s: torch.randn(*s, dtype=torch.bfloat16) * 1.6)(F) * 0.02),
            "w2": _w((lambda *s: torch.randn(*s, dtype=torch.bfloat16) * 1.6)(F, S) * (F ** -0.5)),
            "b2": _w((lambda *s: torch.randn(*s, dtype=torch.bfloat16) * 0.8)(S) * 0.02),
        }
    _B_in = _B_setup()

    return {
        "A_x": _A_in["x"],
        "A_k_cache": _A_in["k_cache"],
        "A_v_cache": _A_in["v_cache"],
        "A_wq": _A_in["wq"],
        "A_wo": _A_in["wo"],
        "B_x": _B_in["x"],
        "B_w1": _B_in["w1"],
        "B_b1": _B_in["b1"],
        "B_w2": _B_in["w2"],
        "B_b2": _B_in["b2"],
    }

def reference(A_x, A_k_cache, A_v_cache, A_wq, A_wo, B_x, B_w1, B_b1, B_w2, B_b2):
    def _A_ref(x, k_cache, v_cache, wq, wo):
        B, Sq, D = x.shape
        Hq, Dh = 32, 192
        Hkv = k_cache.shape[1]
        rep = Hq // Hkv
        q = (lambda x, *d: x.permute(*d))((x @ wq).reshape(B, Sq, Hq, Dh), 0, 2, 1, 3)
        k = (lambda x, n, axis: torch.repeat_interleave(x, n, dim=axis))(k_cache, rep, axis=1)
        v = (lambda x, n, axis: torch.repeat_interleave(x, n, dim=axis))(v_cache, rep, axis=1)
        scores = torch.einsum("bhqd,bhkd->bhqk", q, k) * (Dh ** -0.5)
        p = _softmax(scores, axis=-1)
        o = torch.einsum("bhqk,bhkd->bhqd", p, v)
        return (lambda x, *d: x.permute(*d))(o, 0, 2, 1, 3).reshape(B, Sq, Hq * Dh) @ wo

    def _B_ref(x, w1, b1, w2, b2):
        B, S, D = x.shape
        h = _layernorm(x, axis=-1)
        u = torch.einsum("bsd,sf->bdf", h, w1) + b1
        u = _gelu(u)
        y = torch.einsum("bdf,fs->bds", u, w2) + b2
        return (lambda x, *d: x.permute(*d))(y, 0, 2, 1)

    x = A_x
    h = x + _A_ref(_layernorm(x, axis=-1), A_k_cache, A_v_cache, A_wq, A_wo)
    h2 = h + _B_ref(_layernorm(h, axis=-1), B_w1, B_b1, B_w2, B_b2)
    return h2
```

```asm
; @launch grid=(256,1,1) block=(1024,1,1) lds=75008
.amdgcn_target "amdgcn-amd-amdhsa--gfx950"
.text
.globl sequential_preLN__gqa_block_cached__mixer_token_mlp__decode_kernel
.p2align 8
.type sequential_preLN__gqa_block_cached__mixer_token_mlp__decode_kernel,@function
sequential_preLN__gqa_block_cached__mixer_token_mlp__decode_kernel:
    s_cmp_ge_u32 s2, 256
    s_cbranch_scc1 L_end
    s_load_dwordx16 s[16:31], s[0:1], 0
    s_load_dwordx8 s[32:39], s[0:1], 64
    s_load_dwordx2 s[40:41], s[0:1], 96
    v_lshrrev_b32 v2, 6, v0
    v_and_b32 v3, 63, v0
    v_readfirstlane_b32 s84, v2
    v_mov_b32 v8, 0
    v_lshlrev_b32 v9, 2, v0
    v_cmp_gt_u32 vcc, 32, v0
    s_and_saveexec_b64 s[4:5], vcc
    ds_write_b32 v9, v8 offset:7168
    s_mov_b64 exec, s[4:5]
    v_lshrrev_b32 v4, 3, v3
    v_and_b32 v5, 7, v3
    v_and_b32 v1, 3, v2
    v_mul_u32_u24 v1, 3072, v1
    v_lshrrev_b32 v6, 2, v2
    v_mul_u32_u24 v6, 196608, v6
    v_mul_u32_u24 v4, 384, v4
    v_lshlrev_b32 v5, 4, v5
    v_add3_u32 v1, v1, v4, v5
    v_add_u32 v1, v1, v6
    s_and_b32 s85, s2, 7
    s_lshr_b32 s3, s2, 6
    s_lshl_b32 s3, s3, 3
    s_add_u32 s85, s85, s3
    s_lshr_b32 s86, s2, 3
    s_and_b32 s86, s86, 7
    s_lshr_b32 s87, s86, 2
    s_and_b32 s89, s86, 3
    s_lshl_b32 s88, s87, 5
    s_add_u32 s88, s88, s85
    s_lshl_b32 s3, s88, 2
    s_add_u32 s3, s3, s89
    s_mul_i32 s3, s3, 786432
    s_and_b32 s4, s85, 1
    s_xor_b32 s4, s4, 0
    s_xor_b32 s5, s85, 1
    s_cmp_eq_u32 s4, 0
    s_cbranch_scc0 L_role_light
    s_mov_b32 s13, s85
    s_sub_u32 s99, s86, 3
    s_cmp_ge_u32 s86, 6
    s_cbranch_scc1 L_role_done
    s_cmp_ge_u32 s86, 3
    s_cselect_b32 s13, s5, s85
    s_cselect_b32 s99, s99, s86
    s_branch L_role_done
    L_role_light:
    s_add_u32 s6, s86, 5
    s_cmp_lt_u32 s86, 3
    s_cselect_b32 s13, s5, s85
    s_cselect_b32 s99, s6, s86
    L_role_done:
    s_mov_b32 s94, 0x3d93cd3a
    s_mov_b32 s95, 0x3fb8aa3b
    s_waitcnt lgkmcnt(0)
    s_barrier
    s_load_dwordx2 s[42:43], s[40:41], 0
    s_add_u32 s48, s18, s3
    s_addc_u32 s49, s19, 0
    s_mov_b32 s50, 786432
    s_mov_b32 s51, 0x20000
    s_cmp_lt_u32 s84, 8
    s_cselect_b32 s4, 1, 0
    s_cmp_lt_u32 s99, 3
    s_cselect_b32 s5, s4, 0
    s_cmp_lg_u32 s5, 0
    s_cbranch_scc1 L_qwave
    s_cmp_eq_u32 s84, 0
    s_cbranch_scc1 L_w0_nq
    s_mov_b32 s93, 0
    buffer_load_dwordx4 v[44:47], v1, s[48:51], s93 offen offset:0 nt
    buffer_load_dwordx4 v[48:51], v1, s[48:51], s93 offen offset:128 nt
    buffer_load_dwordx4 v[52:55], v1, s[48:51], s93 offen offset:256 nt
    s_mov_b32 s93, 12288
    buffer_load_dwordx4 v[56:59], v1, s[48:51], s93 offen offset:0 nt
    buffer_load_dwordx4 v[60:63], v1, s[48:51], s93 offen offset:128 nt
    buffer_load_dwordx4 v[64:67], v1, s[48:51], s93 offen offset:256 nt
    s_mov_b32 s93, 24576
    buffer_load_dwordx4 v[68:71], v1, s[48:51], s93 offen offset:0 nt
    buffer_load_dwordx4 v[72:75], v1, s[48:51], s93 offen offset:128 nt
    buffer_load_dwordx4 v[76:79], v1, s[48:51], s93 offen offset:256 nt
    s_mov_b32 s93, 36864
    buffer_load_dwordx4 v[80:83], v1, s[48:51], s93 offen offset:0 nt
    buffer_load_dwordx4 v[84:87], v1, s[48:51], s93 offen offset:128 nt
    buffer_load_dwordx4 v[88:91], v1, s[48:51], s93 offen offset:256 nt
    s_mov_b32 s93, 49152
    buffer_load_dwordx4 v[92:95], v1, s[48:51], s93 offen offset:0 nt
    buffer_load_dwordx4 v[96:99], v1, s[48:51], s93 offen offset:128 nt
    buffer_load_dwordx4 v[100:103], v1, s[48:51], s93 offen offset:256 nt
    s_mov_b32 s93, 61440
    buffer_load_dwordx4 v[104:107], v1, s[48:51], s93 offen offset:0 nt
    buffer_load_dwordx4 v[108:111], v1, s[48:51], s93 offen offset:128 nt
    buffer_load_dwordx4 v[112:115], v1, s[48:51], s93 offen offset:256 nt
    s_mov_b32 s93, 73728
    buffer_load_dwordx4 v[116:119], v1, s[48:51], s93 offen offset:0 nt
    buffer_load_dwordx4 v[120:123], v1, s[48:51], s93 offen offset:128 nt
    buffer_load_dwordx4 v[124:127], v1, s[48:51], s93 offen offset:256 nt
    s_add_u32 s52, s20, s3
    s_addc_u32 s53, s21, 0
    s_mov_b32 s54, 786432
    s_mov_b32 s55, 0x20000
    s_mov_b32 s64, s40
    s_mov_b32 s65, s41
    s_mov_b32 s66, 805306368
    s_mov_b32 s67, 0x20000
    s_mov_b32 s60, s24
    s_mov_b32 s61, s25
    s_mov_b32 s62, 7864320
    s_mov_b32 s63, 0x20000
    s_mov_b32 s68, s28
    s_mov_b32 s69, s29
    s_mov_b32 s70, 3072
    s_mov_b32 s71, 0x20000
    s_mov_b32 s72, s30
    s_mov_b32 s73, s31
    s_mov_b32 s74, 3072
    s_mov_b32 s75, 0x20000
    s_mov_b32 s76, s32
    s_mov_b32 s77, s33
    s_mov_b32 s78, 3072
    s_mov_b32 s79, 0x20000
    s_mov_b32 s80, s36
    s_mov_b32 s81, s37
    s_mov_b32 s82, 2560
    s_mov_b32 s83, 0x20000
    s_mov_b32 s44, s16
    s_mov_b32 s45, s17
    s_mov_b32 s46, 2560
    s_mov_b32 s47, 0x20000
    s_waitcnt lgkmcnt(0)
    s_add_u32 s42, s42, 0x7f4a7c15
    s_addc_u32 s43, s43, 0x9e3779b9
    s_mul_i32 s4, s13, 245760
    s_lshl_b32 s5, s99, 8
    s_add_u32 s4, s4, s5
    s_sub_u32 s4, s4, 768
    s_cmp_ge_u32 s99, 3
    s_cselect_b32 s4, s4, 0x7f000000
    v_lshrrev_b32 v4, 4, v0
    v_mul_u32_u24 v4, 1280, v4
    v_and_b32 v5, 15, v0
    v_lshl_add_u32 v4, v5, 4, v4
    buffer_load_dwordx4 v[24:27], v4, s[60:63], s4 offen nt
    s_add_u32 s4, s4, 81920
    buffer_load_dwordx4 v[28:31], v4, s[60:63], s4 offen nt
    s_add_u32 s4, s4, 81920
    buffer_load_dwordx4 v[40:43], v4, s[60:63], s4 offen nt
    v_mov_b32 v7, 48
    s_mov_b32 s92, 0
L_spin_1:
    ds_read_b32 v2, v7 offset:7168
    s_waitcnt lgkmcnt(0)
    v_readfirstlane_b32 s90, v2
    s_add_u32 s92, s92, 1
    s_cmp_ge_u32 s90, 1
    s_cbranch_scc1 L_sdone_2
    s_cmp_lt_u32 s92, 1048576
    s_cbranch_scc0 L_sdone_2
    s_sleep 2
    s_branch L_spin_1
L_sdone_2:
    s_branch L_q_ready
L_w0_nq:
    s_add_u32 s52, s20, s3
    s_addc_u32 s53, s21, 0
    s_mov_b32 s54, 786432
    s_mov_b32 s55, 0x20000
    s_mov_b32 s64, s40
    s_mov_b32 s65, s41
    s_mov_b32 s66, 805306368
    s_mov_b32 s67, 0x20000
    s_mov_b32 s60, s24
    s_mov_b32 s61, s25
    s_mov_b32 s62, 7864320
    s_mov_b32 s63, 0x20000
    s_mov_b32 s68, s28
    s_mov_b32 s69, s29
    s_mov_b32 s70, 3072
    s_mov_b32 s71, 0x20000
    s_mov_b32 s72, s30
    s_mov_b32 s73, s31
    s_mov_b32 s74, 3072
    s_mov_b32 s75, 0x20000
    s_mov_b32 s76, s32
    s_mov_b32 s77, s33
    s_mov_b32 s78, 3072
    s_mov_b32 s79, 0x20000
    s_mov_b32 s80, s36
    s_mov_b32 s81, s37
    s_mov_b32 s82, 2560
    s_mov_b32 s83, 0x20000
    s_mov_b32 s44, s16
    s_mov_b32 s45, s17
    s_mov_b32 s46, 2560
    s_mov_b32 s47, 0x20000
    s_waitcnt lgkmcnt(0)
    s_add_u32 s42, s42, 0x7f4a7c15
    s_addc_u32 s43, s43, 0x9e3779b9
    s_branch L_w0_poll
L_qwave:
    s_mov_b32 s56, s22
    s_mov_b32 s57, s23
    s_mov_b32 s58, 7864320
    s_mov_b32 s59, 0x20000
    v_lshrrev_b32 v6, 3, v3
    v_lshl_add_u32 v6, v2, 3, v6
    v_and_b32 v7, 7, v3
    s_mul_i32 s4, s13, 384
    s_lshl_b32 s5, s99, 7
    s_add_u32 s5, s4, s5
    v_mul_u32_u24 v40, 12288, v6
    v_lshl_add_u32 v40, v7, 4, v40
    buffer_load_dwordx4 v[64:67], v40, s[56:59], s5 offen nt
    s_add_u32 s5, s5, 786432
    buffer_load_dwordx4 v[68:71], v40, s[56:59], s5 offen nt
    s_add_u32 s5, s5, 786432
    buffer_load_dwordx4 v[72:75], v40, s[56:59], s5 offen nt
    s_add_u32 s5, s5, 786432
    buffer_load_dwordx4 v[76:79], v40, s[56:59], s5 offen nt
    s_add_u32 s5, s5, 786432
    buffer_load_dwordx4 v[80:83], v40, s[56:59], s5 offen nt
    s_add_u32 s5, s5, 786432
    buffer_load_dwordx4 v[84:87], v40, s[56:59], s5 offen nt
    s_add_u32 s5, s5, 786432
    buffer_load_dwordx4 v[88:91], v40, s[56:59], s5 offen nt
    s_add_u32 s5, s5, 786432
    buffer_load_dwordx4 v[92:95], v40, s[56:59], s5 offen nt
    s_add_u32 s5, s5, 786432
    buffer_load_dwordx4 v[96:99], v40, s[56:59], s5 offen nt
    s_add_u32 s5, s5, 786432
    buffer_load_dwordx4 v[100:103], v40, s[56:59], s5 offen nt
    s_mov_b32 s44, s16
    s_mov_b32 s45, s17
    s_mov_b32 s46, 2560
    s_mov_b32 s47, 0x20000
    s_cmp_gt_u32 s84, 1
    s_cbranch_scc1 L_nox
    s_mul_i32 s5, s84, 1280
    v_lshlrev_b32 v7, 2, v3
    buffer_load_dword v24, v7, s[44:47], s5 offen offset:0
    buffer_load_dword v25, v7, s[44:47], s5 offen offset:256
    buffer_load_dword v26, v7, s[44:47], s5 offen offset:512
    buffer_load_dword v27, v7, s[44:47], s5 offen offset:768
    buffer_load_dword v28, v7, s[44:47], s5 offen offset:1024
L_nox:
    s_add_u32 s52, s20, s3
    s_addc_u32 s53, s21, 0
    s_mov_b32 s54, 786432
    s_mov_b32 s55, 0x20000
    s_mov_b32 s64, s40
    s_mov_b32 s65, s41
    s_mov_b32 s66, 805306368
    s_mov_b32 s67, 0x20000
    s_mov_b32 s60, s24
    s_mov_b32 s61, s25
    s_mov_b32 s62, 7864320
    s_mov_b32 s63, 0x20000
    s_mov_b32 s68, s28
    s_mov_b32 s69, s29
    s_mov_b32 s70, 3072
    s_mov_b32 s71, 0x20000
    s_mov_b32 s72, s30
    s_mov_b32 s73, s31
    s_mov_b32 s74, 3072
    s_mov_b32 s75, 0x20000
    s_mov_b32 s76, s32
    s_mov_b32 s77, s33
    s_mov_b32 s78, 3072
    s_mov_b32 s79, 0x20000
    s_mov_b32 s80, s36
    s_mov_b32 s81, s37
    s_mov_b32 s82, 2560
    s_mov_b32 s83, 0x20000
    s_mov_b32 s44, s16
    s_mov_b32 s45, s17
    s_mov_b32 s46, 2560
    s_mov_b32 s47, 0x20000
    s_waitcnt lgkmcnt(0)
    s_add_u32 s42, s42, 0x7f4a7c15
    s_addc_u32 s43, s43, 0x9e3779b9
    s_cmp_gt_u32 s84, 1
    s_cbranch_scc1 L_noln
    s_waitcnt vmcnt(0)
    v_lshlrev_b32 v8, 16, v24
    v_and_b32 v9, 0xffff0000, v24
    v_lshlrev_b32 v10, 16, v25
    v_and_b32 v11, 0xffff0000, v25
    v_lshlrev_b32 v12, 16, v26
    v_and_b32 v13, 0xffff0000, v26
    v_lshlrev_b32 v14, 16, v27
    v_and_b32 v15, 0xffff0000, v27
    v_lshlrev_b32 v16, 16, v28
    v_and_b32 v17, 0xffff0000, v28
    v_readfirstlane_b32 s90, v8
    s_nop 1
    v_mov_b32 v24, s90
    v_mov_b32 v25, s90
    v_pk_add_f32 v[20:21], v[8:9], v[24:25] neg_lo:[0,1] neg_hi:[0,1]
    v_pk_mul_f32 v[18:19], v[20:21], v[20:21]
    v_pk_add_f32 v[26:27], v[10:11], v[24:25] neg_lo:[0,1] neg_hi:[0,1]
    v_pk_add_f32 v[20:21], v[20:21], v[26:27]
    v_pk_fma_f32 v[18:19], v[26:27], v[26:27], v[18:19]
    v_pk_add_f32 v[26:27], v[12:13], v[24:25] neg_lo:[0,1] neg_hi:[0,1]
    v_pk_add_f32 v[20:21], v[20:21], v[26:27]
    v_pk_fma_f32 v[18:19], v[26:27], v[26:27], v[18:19]
    v_pk_add_f32 v[26:27], v[14:15], v[24:25] neg_lo:[0,1] neg_hi:[0,1]
    v_pk_add_f32 v[20:21], v[20:21], v[26:27]
    v_pk_fma_f32 v[18:19], v[26:27], v[26:27], v[18:19]
    v_pk_add_f32 v[26:27], v[16:17], v[24:25] neg_lo:[0,1] neg_hi:[0,1]
    v_pk_add_f32 v[20:21], v[20:21], v[26:27]
    v_pk_fma_f32 v[18:19], v[26:27], v[26:27], v[18:19]
    v_add_f32 v20, v20, v21
    v_add_f32 v18, v18, v19
    s_nop 1
    v_add_f32_dpp v20, v20, v20 quad_perm:[1,0,3,2] row_mask:0xf bank_mask:0xf
    v_add_f32_dpp v18, v18, v18 quad_perm:[1,0,3,2] row_mask:0xf bank_mask:0xf
    s_nop 1
    v_add_f32_dpp v20, v20, v20 quad_perm:[2,3,0,1] row_mask:0xf bank_mask:0xf
    v_add_f32_dpp v18, v18, v18 quad_perm:[2,3,0,1] row_mask:0xf bank_mask:0xf
    s_nop 1
    v_add_f32_dpp v20, v20, v20 row_half_mirror row_mask:0xf bank_mask:0xf
    v_add_f32_dpp v18, v18, v18 row_half_mirror row_mask:0xf bank_mask:0xf
    s_nop 1
    v_add_f32_dpp v20, v20, v20 row_mirror row_mask:0xf bank_mask:0xf
    v_add_f32_dpp v18, v18, v18 row_mirror row_mask:0xf bank_mask:0xf
    v_mov_b32 v26, v20
    v_mov_b32 v27, v18
    s_nop 1
    v_permlane16_swap_b32 v20, v26
    v_permlane16_swap_b32 v18, v27
    s_nop 0
    v_add_f32 v20, v20, v26
    v_add_f32 v18, v18, v27
    v_mov_b32 v26, v20
    v_mov_b32 v27, v18
    s_nop 1
    v_permlane32_swap_b32 v20, v26
    v_permlane32_swap_b32 v18, v27
    s_nop 0
    v_add_f32 v20, v20, v26
    v_add_f32 v18, v18, v27
    v_mul_f32 v20, 0x3acccccd, v20
    v_mul_f32 v18, 0x3acccccd, v18
    v_fma_f32 v18, -v20, v20, v18
    v_add_f32 v20, v20, v24
    v_max_f32 v18, 0, v18
    v_cvt_pk_bf16_f32 v26, v18, v20
    v_lshlrev_b32 v18, 16, v26
    v_and_b32 v20, 0xffff0000, v26
    v_add_f32 v18, 0x3727c5ac, v18
    v_cvt_pk_bf16_f32 v26, v18, v18
    v_lshlrev_b32 v18, 16, v26
    v_sqrt_f32 v18, v18
    v_mov_b32 v21, v20
    v_cvt_pk_bf16_f32 v26, v18, v18
    v_lshlrev_b32 v18, 16, v26
    v_rcp_f32 v22, v18
    s_nop 0
    v_mov_b32 v23, v22
    v_pk_add_f32 v[8:9], v[8:9], v[20:21] neg_lo:[0,1] neg_hi:[0,1]
    v_pk_add_f32 v[10:11], v[10:11], v[20:21] neg_lo:[0,1] neg_hi:[0,1]
    v_pk_add_f32 v[12:13], v[12:13], v[20:21] neg_lo:[0,1] neg_hi:[0,1]
    v_pk_add_f32 v[14:15], v[14:15], v[20:21] neg_lo:[0,1] neg_hi:[0,1]
    v_pk_add_f32 v[16:17], v[16:17], v[20:21] neg_lo:[0,1] neg_hi:[0,1]
    v_cvt_pk_bf16_f32 v26, v8, v9
    v_lshlrev_b32 v8, 16, v26
    v_and_b32 v9, 0xffff0000, v26
    v_cvt_pk_bf16_f32 v27, v10, v11
    v_lshlrev_b32 v10, 16, v27
    v_and_b32 v11, 0xffff0000, v27
    v_cvt_pk_bf16_f32 v26, v12, v13
    v_lshlrev_b32 v12, 16, v26
    v_and_b32 v13, 0xffff0000, v26
    v_cvt_pk_bf16_f32 v27, v14, v15
    v_lshlrev_b32 v14, 16, v27
    v_and_b32 v15, 0xffff0000, v27
    v_cvt_pk_bf16_f32 v26, v16, v17
    v_lshlrev_b32 v16, 16, v26
    v_and_b32 v17, 0xffff0000, v26
    v_pk_mul_f32 v[8:9], v[8:9], v[22:23]
    v_pk_mul_f32 v[10:11], v[10:11], v[22:23]
    v_pk_mul_f32 v[12:13], v[12:13], v[22:23]
    v_pk_mul_f32 v[14:15], v[14:15], v[22:23]
    v_pk_mul_f32 v[16:17], v[16:17], v[22:23]
    s_mul_i32 s5, s84, 1280
    v_lshlrev_b32 v7, 2, v3
    v_add_u32 v7, s5, v7
    v_cvt_pk_bf16_f32 v28, v8, v9
    ds_write_b32 v7, v28 offset:0
    v_cvt_pk_bf16_f32 v29, v10, v11
    ds_write_b32 v7, v29 offset:256
    v_cvt_pk_bf16_f32 v30, v12, v13
    ds_write_b32 v7, v30 offset:512
    v_cvt_pk_bf16_f32 v31, v14, v15
    ds_write_b32 v7, v31 offset:768
    v_cvt_pk_bf16_f32 v32, v16, v17
    ds_write_b32 v7, v32 offset:1024
    v_mov_b32 v44, v6
    v_mov_b32 v6, 56
    v_mov_b32 v7, 1
    s_waitcnt lgkmcnt(0)
    s_mov_b32 exec_lo, 0x1
    s_mov_b32 exec_hi, 0x0
    ds_add_rtn_u32 v7, v6, v7 offset:7168
    s_waitcnt lgkmcnt(0)
    v_readfirstlane_b32 s5, v7
    s_mov_b64 exec, -1
    v_mov_b32 v6, v44
L_noln:
    v_mov_b32 v7, 56
    s_mov_b32 s92, 0
L_spin_3:
    ds_read_b32 v2, v7 offset:7168
    s_waitcnt lgkmcnt(0)
    v_readfirstlane_b32 s90, v2
    s_add_u32 s92, s92, 1
    s_cmp_ge_u32 s90, 2
    s_cbranch_scc1 L_sdone_4
    s_cmp_lt_u32 s92, 1048576
    s_cbranch_scc0 L_sdone_4
    s_sleep 1
    s_branch L_spin_3
L_sdone_4:
    v_lshlrev_b32 v7, 1, v6
    ds_read_u16 v44, v7 offset:0
    ds_read_u16 v45, v7 offset:1280
    ds_read_u16 v46, v7 offset:128
    ds_read_u16 v47, v7 offset:1408
    ds_read_u16 v48, v7 offset:256
    ds_read_u16 v49, v7 offset:1536
    ds_read_u16 v50, v7 offset:384
    ds_read_u16 v51, v7 offset:1664
    ds_read_u16 v52, v7 offset:512
    ds_read_u16 v53, v7 offset:1792
    ds_read_u16 v54, v7 offset:640
    ds_read_u16 v55, v7 offset:1920
    ds_read_u16 v56, v7 offset:768
    ds_read_u16 v57, v7 offset:2048
    s_waitcnt lgkmcnt(0)
    ds_read_u16 v58, v7 offset:896
    ds_read_u16 v59, v7 offset:2176
    ds_read_u16 v60, v7 offset:1024
    ds_read_u16 v61, v7 offset:2304
    ds_read_u16 v62, v7 offset:1152
    ds_read_u16 v63, v7 offset:2432
    s_waitcnt lgkmcnt(0)
    v_lshlrev_b32 v30, 16, v44
    v_lshlrev_b32 v31, 16, v45
    s_waitcnt vmcnt(9)
    v_dot2_f32_bf16 v8, v64, v44, 0
    v_dot2_f32_bf16 v9, v64, v30, 0
    v_dot2_f32_bf16 v16, v64, v45, 0
    v_dot2_f32_bf16 v17, v64, v31, 0
    v_dot2_f32_bf16 v10, v65, v44, 0
    v_dot2_f32_bf16 v11, v65, v30, 0
    v_dot2_f32_bf16 v18, v65, v45, 0
    v_dot2_f32_bf16 v19, v65, v31, 0
    v_dot2_f32_bf16 v12, v66, v44, 0
    v_dot2_f32_bf16 v13, v66, v30, 0
    v_dot2_f32_bf16 v20, v66, v45, 0
    v_dot2_f32_bf16 v21, v66, v31, 0
    v_dot2_f32_bf16 v14, v67, v44, 0
    v_dot2_f32_bf16 v15, v67, v30, 0
    v_dot2_f32_bf16 v22, v67, v45, 0
    v_dot2_f32_bf16 v23, v67, v31, 0
    v_lshlrev_b32 v30, 16, v46
    v_lshlrev_b32 v31, 16, v47
    s_waitcnt vmcnt(8)
    v_dot2_f32_bf16 v8, v68, v46, v8
    v_dot2_f32_bf16 v9, v68, v30, v9
    v_dot2_f32_bf16 v16, v68, v47, v16
    v_dot2_f32_bf16 v17, v68, v31, v17
    v_dot2_f32_bf16 v10, v69, v46, v10
    v_dot2_f32_bf16 v11, v69, v30, v11
    v_dot2_f32_bf16 v18, v69, v47, v18
    v_dot2_f32_bf16 v19, v69, v31, v19
    v_dot2_f32_bf16 v12, v70, v46, v12
    v_dot2_f32_bf16 v13, v70, v30, v13
    v_dot2_f32_bf16 v20, v70, v47, v20
    v_dot2_f32_bf16 v21, v70, v31, v21
    v_dot2_f32_bf16 v14, v71, v46, v14
    v_dot2_f32_bf16 v15, v71, v30, v15
    v_dot2_f32_bf16 v22, v71, v47, v22
    v_dot2_f32_bf16 v23, v71, v31, v23
    v_lshlrev_b32 v30, 16, v48
    v_lshlrev_b32 v31, 16, v49
    s_waitcnt vmcnt(7)
    v_dot2_f32_bf16 v8, v72, v48, v8
    v_dot2_f32_bf16 v9, v72, v30, v9
    v_dot2_f32_bf16 v16, v72, v49, v16
    v_dot2_f32_bf16 v17, v72, v31, v17
    v_dot2_f32_bf16 v10, v73, v48, v10
    v_dot2_f32_bf16 v11, v73, v30, v11
    v_dot2_f32_bf16 v18, v73, v49, v18
    v_dot2_f32_bf16 v19, v73, v31, v19
    v_dot2_f32_bf16 v12, v74, v48, v12
    v_dot2_f32_bf16 v13, v74, v30, v13
    v_dot2_f32_bf16 v20, v74, v49, v20
    v_dot2_f32_bf16 v21, v74, v31, v21
    v_dot2_f32_bf16 v14, v75, v48, v14
    v_dot2_f32_bf16 v15, v75, v30, v15
    v_dot2_f32_bf16 v22, v75, v49, v22
    v_dot2_f32_bf16 v23, v75, v31, v23
    v_lshlrev_b32 v30, 16, v50
    v_lshlrev_b32 v31, 16, v51
    s_waitcnt vmcnt(6)
    v_dot2_f32_bf16 v8, v76, v50, v8
    v_dot2_f32_bf16 v9, v76, v30, v9
    v_dot2_f32_bf16 v16, v76, v51, v16
    v_dot2_f32_bf16 v17, v76, v31, v17
    v_dot2_f32_bf16 v10, v77, v50, v10
    v_dot2_f32_bf16 v11, v77, v30, v11
    v_dot2_f32_bf16 v18, v77, v51, v18
    v_dot2_f32_bf16 v19, v77, v31, v19
    v_dot2_f32_bf16 v12, v78, v50, v12
    v_dot2_f32_bf16 v13, v78, v30, v13
    v_dot2_f32_bf16 v20, v78, v51, v20
    v_dot2_f32_bf16 v21, v78, v31, v21
    v_dot2_f32_bf16 v14, v79, v50, v14
    v_dot2_f32_bf16 v15, v79, v30, v15
    v_dot2_f32_bf16 v22, v79, v51, v22
    v_dot2_f32_bf16 v23, v79, v31, v23
    v_lshlrev_b32 v30, 16, v52
    v_lshlrev_b32 v31, 16, v53
    s_waitcnt vmcnt(5)
    v_dot2_f32_bf16 v8, v80, v52, v8
    v_dot2_f32_bf16 v9, v80, v30, v9
    v_dot2_f32_bf16 v16, v80, v53, v16
    v_dot2_f32_bf16 v17, v80, v31, v17
    v_dot2_f32_bf16 v10, v81, v52, v10
    v_dot2_f32_bf16 v11, v81, v30, v11
    v_dot2_f32_bf16 v18, v81, v53, v18
    v_dot2_f32_bf16 v19, v81, v31, v19
    v_dot2_f32_bf16 v12, v82, v52, v12
    v_dot2_f32_bf16 v13, v82, v30, v13
    v_dot2_f32_bf16 v20, v82, v53, v20
    v_dot2_f32_bf16 v21, v82, v31, v21
    v_dot2_f32_bf16 v14, v83, v52, v14
    v_dot2_f32_bf16 v15, v83, v30, v15
    v_dot2_f32_bf16 v22, v83, v53, v22
    v_dot2_f32_bf16 v23, v83, v31, v23
    v_lshlrev_b32 v30, 16, v54
    v_lshlrev_b32 v31, 16, v55
    s_waitcnt vmcnt(4)
    v_dot2_f32_bf16 v8, v84, v54, v8
    v_dot2_f32_bf16 v9, v84, v30, v9
    v_dot2_f32_bf16 v16, v84, v55, v16
    v_dot2_f32_bf16 v17, v84, v31, v17
    v_dot2_f32_bf16 v10, v85, v54, v10
    v_dot2_f32_bf16 v11, v85, v30, v11
    v_dot2_f32_bf16 v18, v85, v55, v18
    v_dot2_f32_bf16 v19, v85, v31, v19
    v_dot2_f32_bf16 v12, v86, v54, v12
    v_dot2_f32_bf16 v13, v86, v30, v13
    v_dot2_f32_bf16 v20, v86, v55, v20
    v_dot2_f32_bf16 v21, v86, v31, v21
    v_dot2_f32_bf16 v14, v87, v54, v14
    v_dot2_f32_bf16 v15, v87, v30, v15
    v_dot2_f32_bf16 v22, v87, v55, v22
    v_dot2_f32_bf16 v23, v87, v31, v23
    v_lshlrev_b32 v30, 16, v56
    v_lshlrev_b32 v31, 16, v57
    s_waitcnt vmcnt(3)
    v_dot2_f32_bf16 v8, v88, v56, v8
    v_dot2_f32_bf16 v9, v88, v30, v9
    v_dot2_f32_bf16 v16, v88, v57, v16
    v_dot2_f32_bf16 v17, v88, v31, v17
    v_dot2_f32_bf16 v10, v89, v56, v10
    v_dot2_f32_bf16 v11, v89, v30, v11
    v_dot2_f32_bf16 v18, v89, v57, v18
    v_dot2_f32_bf16 v19, v89, v31, v19
    v_dot2_f32_bf16 v12, v90, v56, v12
    v_dot2_f32_bf16 v13, v90, v30, v13
    v_dot2_f32_bf16 v20, v90, v57, v20
    v_dot2_f32_bf16 v21, v90, v31, v21
    v_dot2_f32_bf16 v14, v91, v56, v14
    v_dot2_f32_bf16 v15, v91, v30, v15
    v_dot2_f32_bf16 v22, v91, v57, v22
    v_dot2_f32_bf16 v23, v91, v31, v23
    v_lshlrev_b32 v30, 16, v58
    v_lshlrev_b32 v31, 16, v59
    s_waitcnt vmcnt(2)
    v_dot2_f32_bf16 v8, v92, v58, v8
    v_dot2_f32_bf16 v9, v92, v30, v9
    v_dot2_f32_bf16 v16, v92, v59, v16
    v_dot2_f32_bf16 v17, v92, v31, v17
    v_dot2_f32_bf16 v10, v93, v58, v10
    v_dot2_f32_bf16 v11, v93, v30, v11
    v_dot2_f32_bf16 v18, v93, v59, v18
    v_dot2_f32_bf16 v19, v93, v31, v19
    v_dot2_f32_bf16 v12, v94, v58, v12
    v_dot2_f32_bf16 v13, v94, v30, v13
    v_dot2_f32_bf16 v20, v94, v59, v20
    v_dot2_f32_bf16 v21, v94, v31, v21
    v_dot2_f32_bf16 v14, v95, v58, v14
    v_dot2_f32_bf16 v15, v95, v30, v15
    v_dot2_f32_bf16 v22, v95, v59, v22
    v_dot2_f32_bf16 v23, v95, v31, v23
    v_lshlrev_b32 v30, 16, v60
    v_lshlrev_b32 v31, 16, v61
    s_waitcnt vmcnt(1)
    v_dot2_f32_bf16 v8, v96, v60, v8
    v_dot2_f32_bf16 v9, v96, v30, v9
    v_dot2_f32_bf16 v16, v96, v61, v16
    v_dot2_f32_bf16 v17, v96, v31, v17
    v_dot2_f32_bf16 v10, v97, v60, v10
    v_dot2_f32_bf16 v11, v97, v30, v11
    v_dot2_f32_bf16 v18, v97, v61, v18
    v_dot2_f32_bf16 v19, v97, v31, v19
    v_dot2_f32_bf16 v12, v98, v60, v12
    v_dot2_f32_bf16 v13, v98, v30, v13
    v_dot2_f32_bf16 v20, v98, v61, v20
    v_dot2_f32_bf16 v21, v98, v31, v21
    v_dot2_f32_bf16 v14, v99, v60, v14
    v_dot2_f32_bf16 v15, v99, v30, v15
    v_dot2_f32_bf16 v22, v99, v61, v22
    v_dot2_f32_bf16 v23, v99, v31, v23
    v_lshlrev_b32 v30, 16, v62
    v_lshlrev_b32 v31, 16, v63
    s_waitcnt vmcnt(0)
    v_dot2_f32_bf16 v8, v100, v62, v8
    v_dot2_f32_bf16 v9, v100, v30, v9
    v_dot2_f32_bf16 v16, v100, v63, v16
    v_dot2_f32_bf16 v17, v100, v31, v17
    v_dot2_f32_bf16 v10, v101, v62, v10
    v_dot2_f32_bf16 v11, v101, v30, v11
    v_dot2_f32_bf16 v18, v101, v63, v18
    v_dot2_f32_bf16 v19, v101, v31, v19
    v_dot2_f32_bf16 v12, v102, v62, v12
    v_dot2_f32_bf16 v13, v102, v30, v13
    v_dot2_f32_bf16 v20, v102, v63, v20
    v_dot2_f32_bf16 v21, v102, v31, v21
    v_dot2_f32_bf16 v14, v103, v62, v14
    v_dot2_f32_bf16 v15, v103, v30, v15
    v_dot2_f32_bf16 v22, v103, v63, v22
    v_dot2_f32_bf16 v23, v103, v31, v23
    s_nop 2
    v_permlane32_swap_b32 v8, v16
    v_permlane32_swap_b32 v9, v17
    v_permlane32_swap_b32 v10, v18
    v_permlane32_swap_b32 v11, v19
    v_permlane32_swap_b32 v12, v20
    v_permlane32_swap_b32 v13, v21
    v_permlane32_swap_b32 v14, v22
    v_permlane32_swap_b32 v15, v23
    s_nop 0
    v_add_f32 v8, v8, v16
    v_add_f32 v9, v9, v17
    v_add_f32 v10, v10, v18
    v_add_f32 v11, v11, v19
    v_add_f32 v12, v12, v20
    v_add_f32 v13, v13, v21
    v_add_f32 v14, v14, v22
    v_add_f32 v15, v15, v23
    s_nop 1
    v_permlane16_swap_b32 v8, v12
    v_permlane16_swap_b32 v9, v13
    v_permlane16_swap_b32 v10, v14
    v_permlane16_swap_b32 v11, v15
    s_nop 0
    v_add_f32 v8, v8, v12
    v_add_f32 v9, v9, v13
    v_add_f32 v10, v10, v14
    v_add_f32 v11, v11, v15
    s_nop 1
    v_add_f32_dpp v8, v8, v8 row_ror:8 row_mask:0xf bank_mask:0xf
    v_add_f32_dpp v9, v9, v9 row_ror:8 row_mask:0xf bank_mask:0xf
    v_add_f32_dpp v10, v10, v10 row_ror:8 row_mask:0xf bank_mask:0xf
    v_add_f32_dpp v11, v11, v11 row_ror:8 row_mask:0xf bank_mask:0xf
    v_lshrrev_b32 v4, 5, v3
    v_lshlrev_b32 v4, 8, v4
    v_and_b32 v5, 7, v3
    v_lshl_add_u32 v4, v5, 5, v4
    v_and_b32 v5, 16, v3
    v_add_u32 v4, v4, v5
    s_lshl_b32 s5, s84, 9
    v_add_u32 v4, s5, v4
    s_mov_b32 exec_lo, 0xff00ff
    s_mov_b32 exec_hi, 0xff00ff
    ds_write_b128 v4, v[8:11] offset:2560
    s_mov_b64 exec, -1
    v_mov_b32 v6, 60
    v_mov_b32 v7, 1
    s_waitcnt lgkmcnt(0)
    s_mov_b32 exec_lo, 0x1
    s_mov_b32 exec_hi, 0x0
    ds_add_rtn_u32 v7, v6, v7 offset:7168
    s_waitcnt lgkmcnt(0)
    v_readfirstlane_b32 s5, v7
    s_mov_b64 exec, -1
    s_cmp_eq_u32 s84, 0
    s_cbranch_scc1 L_w0_q
    s_mov_b32 s93, 0
    buffer_load_dwordx4 v[44:47], v1, s[48:51], s93 offen offset:0 nt
    buffer_load_dwordx4 v[48:51], v1, s[48:51], s93 offen offset:128 nt
    buffer_load_dwordx4 v[52:55], v1, s[48:51], s93 offen offset:256 nt
    s_mov_b32 s93, 12288
    buffer_load_dwordx4 v[56:59], v1, s[48:51], s93 offen offset:0 nt
    buffer_load_dwordx4 v[60:63], v1, s[48:51], s93 offen offset:128 nt
    buffer_load_dwordx4 v[64:67], v1, s[48:51], s93 offen offset:256 nt
    s_mov_b32 s93, 24576
    buffer_load_dwordx4 v[68:71], v1, s[48:51], s93 offen offset:0 nt
    buffer_load_dwordx4 v[72:75], v1, s[48:51], s93 offen offset:128 nt
    buffer_load_dwordx4 v[76:79], v1, s[48:51], s93 offen offset:256 nt
    s_mov_b32 s93, 36864
    buffer_load_dwordx4 v[80:83], v1, s[48:51], s93 offen offset:0 nt
    buffer_load_dwordx4 v[84:87], v1, s[48:51], s93 offen offset:128 nt
    buffer_load_dwordx4 v[88:91], v1, s[48:51], s93 offen offset:256 nt
    s_mov_b32 s93, 49152
    buffer_load_dwordx4 v[92:95], v1, s[48:51], s93 offen offset:0 nt
    buffer_load_dwordx4 v[96:99], v1, s[48:51], s93 offen offset:128 nt
    buffer_load_dwordx4 v[100:103], v1, s[48:51], s93 offen offset:256 nt
    s_mov_b32 s93, 61440
    buffer_load_dwordx4 v[104:107], v1, s[48:51], s93 offen offset:0 nt
    buffer_load_dwordx4 v[108:111], v1, s[48:51], s93 offen offset:128 nt
    buffer_load_dwordx4 v[112:115], v1, s[48:51], s93 offen offset:256 nt
    s_mov_b32 s93, 73728
    buffer_load_dwordx4 v[116:119], v1, s[48:51], s93 offen offset:0 nt
    buffer_load_dwordx4 v[120:123], v1, s[48:51], s93 offen offset:128 nt
    buffer_load_dwordx4 v[124:127], v1, s[48:51], s93 offen offset:256 nt
    s_mul_i32 s4, s13, 245760
    s_lshl_b32 s5, s99, 8
    s_add_u32 s4, s4, s5
    s_sub_u32 s4, s4, 768
    s_cmp_ge_u32 s99, 3
    s_cselect_b32 s4, s4, 0x7f000000
    v_lshrrev_b32 v4, 4, v0
    v_mul_u32_u24 v4, 1280, v4
    v_and_b32 v5, 15, v0
    v_lshl_add_u32 v4, v5, 4, v4
    buffer_load_dwordx4 v[24:27], v4, s[60:63], s4 offen nt
    s_add_u32 s4, s4, 81920
    buffer_load_dwordx4 v[28:31], v4, s[60:63], s4 offen nt
    s_add_u32 s4, s4, 81920
    buffer_load_dwordx4 v[40:43], v4, s[60:63], s4 offen nt
    v_mov_b32 v7, 48
    s_mov_b32 s92, 0
L_spin_5:
    ds_read_b32 v2, v7 offset:7168
    s_waitcnt lgkmcnt(0)
    v_readfirstlane_b32 s90, v2
    s_add_u32 s92, s92, 1
    s_cmp_ge_u32 s90, 1
    s_cbranch_scc1 L_sdone_6
    s_cmp_lt_u32 s92, 1048576
    s_cbranch_scc0 L_sdone_6
    s_sleep 2
    s_branch L_spin_5
L_sdone_6:
    s_branch L_q_ready
L_w0_q:
    v_mov_b32 v7, 60
    s_mov_b32 s92, 0
L_spin_7:
    ds_read_b32 v2, v7 offset:7168
    s_waitcnt lgkmcnt(0)
    v_readfirstlane_b32 s90, v2
    s_add_u32 s92, s92, 1
    s_cmp_ge_u32 s90, 8
    s_cbranch_scc1 L_sdone_8
    s_cmp_lt_u32 s92, 1048576
    s_cbranch_scc0 L_sdone_8
    s_sleep 1
    s_branch L_spin_7
L_sdone_8:
    v_lshlrev_b32 v7, 4, v3
    s_mov_b32 exec_lo, 0xffffffff
    s_mov_b32 exec_hi, 0x0
    ds_read_b128 v[44:47], v7 offset:2560
    ds_read_b128 v[48:51], v7 offset:3072
    ds_read_b128 v[52:55], v7 offset:3584
    ds_read_b128 v[56:59], v7 offset:4096
    ds_read_b128 v[60:63], v7 offset:4608
    ds_read_b128 v[64:67], v7 offset:5120
    ds_read_b128 v[68:71], v7 offset:5632
    ds_read_b128 v[72:75], v7 offset:6144
    s_waitcnt lgkmcnt(0)
    v_pk_add_f32 v[44:45], v[44:45], v[60:61]
    v_pk_add_f32 v[46:47], v[46:47], v[62:63]
    v_pk_add_f32 v[48:49], v[48:49], v[64:65]
    v_pk_add_f32 v[50:51], v[50:51], v[66:67]
    v_pk_add_f32 v[52:53], v[52:53], v[68:69]
    v_pk_add_f32 v[54:55], v[54:55], v[70:71]
    v_pk_add_f32 v[56:57], v[56:57], v[72:73]
    v_pk_add_f32 v[58:59], v[58:59], v[74:75]
    v_pk_add_f32 v[44:45], v[44:45], v[52:53]
    v_pk_add_f32 v[46:47], v[46:47], v[54:55]
    v_pk_add_f32 v[48:49], v[48:49], v[56:57]
    v_pk_add_f32 v[50:51], v[50:51], v[58:59]
    v_pk_add_f32 v[44:45], v[44:45], v[48:49]
    v_pk_add_f32 v[46:47], v[46:47], v[50:51]
    v_cvt_pk_bf16_f32 v12, v44, v45
    v_cvt_pk_bf16_f32 v13, v46, v47
    v_mov_b32 v14, s42
    v_mov_b32 v15, s43
    v_lshrrev_b32 v4, 4, v3
    v_mul_u32_u24 v4, 512, v4
    v_add_u32 v4, v4, v7
    s_mul_i32 s4, s13, 96
    s_lshl_b32 s5, s99, 4
    s_add_u32 s4, s4, s5
    s_lshl_b32 s4, s4, 4
    s_add_u32 s4, s4, 4096
    buffer_store_dwordx4 v[12:15], v4, s[64:67], s4 offen sc1
L_w0_poll:
    s_mov_b32 exec_lo, 0xffffffff
    s_mov_b32 exec_hi, 0xffff
    s_mul_i32 s4, s85, 96
    s_mul_i32 s5, s87, 48
    s_add_u32 s4, s4, s5
    s_lshl_b32 s4, s4, 4
    s_add_u32 s4, s4, 4096
    v_lshlrev_b32 v4, 4, v3
    s_mov_b32 s92, 0
L_poll_9:
    buffer_load_dwordx4 v[16:19], v4, s[64:67], s4 offen sc1
    s_waitcnt vmcnt(0)
    v_cmp_ne_u64 vcc, s[42:43], v[18:19]
    s_cbranch_vccz L_pdone_10
    s_add_u32 s92, s92, 1
    s_cmp_lt_u32 s92, 65536
    s_cbranch_scc0 L_pdone_10
    s_sleep 4
    s_branch L_poll_9
L_pdone_10:
    v_lshlrev_b32 v4, 3, v3
    ds_write_b64 v4, v[16:17] offset:6656
    s_mov_b64 exec, -1
    v_mov_b32 v4, 1
    v_mov_b32 v5, 0
    s_waitcnt lgkmcnt(0)
    ds_write_b32 v5, v4 offset:7216
    s_mov_b32 s93, 0
    buffer_load_dwordx4 v[44:47], v1, s[48:51], s93 offen offset:0 nt
    buffer_load_dwordx4 v[48:51], v1, s[48:51], s93 offen offset:128 nt
    buffer_load_dwordx4 v[52:55], v1, s[48:51], s93 offen offset:256 nt
    s_mov_b32 s93, 12288
    buffer_load_dwordx4 v[56:59], v1, s[48:51], s93 offen offset:0 nt
    buffer_load_dwordx4 v[60:63], v1, s[48:51], s93 offen offset:128 nt
    buffer_load_dwordx4 v[64:67], v1, s[48:51], s93 offen offset:256 nt
    s_mov_b32 s93, 24576
    buffer_load_dwordx4 v[68:71], v1, s[48:51], s93 offen offset:0 nt
    buffer_load_dwordx4 v[72:75], v1, s[48:51], s93 offen offset:128 nt
    buffer_load_dwordx4 v[76:79], v1, s[48:51], s93 offen offset:256 nt
    s_mov_b32 s93, 36864
    buffer_load_dwordx4 v[80:83], v1, s[48:51], s93 offen offset:0 nt
    buffer_load_dwordx4 v[84:87], v1, s[48:51], s93 offen offset:128 nt
    buffer_load_dwordx4 v[88:91], v1, s[48:51], s93 offen offset:256 nt
    s_mov_b32 s93, 49152
    buffer_load_dwordx4 v[92:95], v1, s[48:51], s93 offen offset:0 nt
    buffer_load_dwordx4 v[96:99], v1, s[48:51], s93 offen offset:128 nt
    buffer_load_dwordx4 v[100:103], v1, s[48:51], s93 offen offset:256 nt
    s_mov_b32 s93, 61440
    buffer_load_dwordx4 v[104:107], v1, s[48:51], s93 offen offset:0 nt
    buffer_load_dwordx4 v[108:111], v1, s[48:51], s93 offen offset:128 nt
    buffer_load_dwordx4 v[112:115], v1, s[48:51], s93 offen offset:256 nt
    s_mov_b32 s93, 73728
    buffer_load_dwordx4 v[116:119], v1, s[48:51], s93 offen offset:0 nt
    buffer_load_dwordx4 v[120:123], v1, s[48:51], s93 offen offset:128 nt
    buffer_load_dwordx4 v[124:127], v1, s[48:51], s93 offen offset:256 nt
    s_mul_i32 s4, s13, 245760
    s_lshl_b32 s5, s99, 8
    s_add_u32 s4, s4, s5
    s_sub_u32 s4, s4, 768
    s_cmp_ge_u32 s99, 3
    s_cselect_b32 s4, s4, 0x7f000000
    v_lshrrev_b32 v4, 4, v0
    v_mul_u32_u24 v4, 1280, v4
    v_and_b32 v5, 15, v0
    v_lshl_add_u32 v4, v5, 4, v4
    buffer_load_dwordx4 v[24:27], v4, s[60:63], s4 offen nt
    s_add_u32 s4, s4, 81920
    buffer_load_dwordx4 v[28:31], v4, s[60:63], s4 offen nt
    s_add_u32 s4, s4, 81920
    buffer_load_dwordx4 v[40:43], v4, s[60:63], s4 offen nt
L_q_ready:
    v_and_b32 v5, 7, v3
    v_lshlrev_b32 v5, 4, v5
    ds_read_b128 v[8:11], v5 offset:6656
    ds_read_b128 v[12:15], v5 offset:6784
    ds_read_b128 v[16:19], v5 offset:6912
    s_waitcnt lgkmcnt(0)
    s_waitcnt vmcnt(21)
    v_dot2_f32_bf16 v20, v44, v8, 0
    v_dot2_f32_bf16 v21, v48, v12, 0
    v_dot2_f32_bf16 v22, v52, v16, 0
    v_dot2_f32_bf16 v20, v45, v9, v20
    v_dot2_f32_bf16 v21, v49, v13, v21
    v_dot2_f32_bf16 v22, v53, v17, v22
    v_dot2_f32_bf16 v20, v46, v10, v20
    v_dot2_f32_bf16 v21, v50, v14, v21
    v_dot2_f32_bf16 v22, v54, v18, v22
    v_dot2_f32_bf16 v20, v47, v11, v20
    v_dot2_f32_bf16 v21, v51, v15, v21
    v_dot2_f32_bf16 v22, v55, v19, v22
    s_mov_b32 s93, 86016
    buffer_load_dwordx4 v[44:47], v1, s[48:51], s93 offen offset:0 nt
    buffer_load_dwordx4 v[48:51], v1, s[48:51], s93 offen offset:128 nt
    buffer_load_dwordx4 v[52:55], v1, s[48:51], s93 offen offset:256 nt
    v_add_f32 v4, v20, v21
    v_add_f32 v4, v4, v22
    s_nop 1
    v_add_f32_dpp v4, v4, v4 quad_perm:[1,0,3,2] row_mask:0xf bank_mask:0xf
    s_nop 1
    v_add_f32_dpp v4, v4, v4 quad_perm:[2,3,0,1] row_mask:0xf bank_mask:0xf
    s_nop 1
    v_add_f32_dpp v4, v4, v4 row_half_mirror row_mask:0xf bank_mask:0xf
    s_waitcnt vmcnt(21)
    v_dot2_f32_bf16 v20, v56, v8, 0
    v_dot2_f32_bf16 v21, v60, v12, 0
    v_dot2_f32_bf16 v22, v64, v16, 0
    v_dot2_f32_bf16 v20, v57, v9, v20
    v_dot2_f32_bf16 v21, v61, v13, v21
    v_dot2_f32_bf16 v22, v65, v17, v22
    v_dot2_f32_bf16 v20, v58, v10, v20
    v_dot2_f32_bf16 v21, v62, v14, v21
    v_dot2_f32_bf16 v22, v66, v18, v22
    v_dot2_f32_bf16 v20, v59, v11, v20
    v_dot2_f32_bf16 v21, v63, v15, v21
    v_dot2_f32_bf16 v22, v67, v19, v22
    s_mov_b32 s93, 98304
    buffer_load_dwordx4 v[56:59], v1, s[48:51], s93 offen offset:0 nt
    buffer_load_dwordx4 v[60:63], v1, s[48:51], s93 offen offset:128 nt
    buffer_load_dwordx4 v[64:67], v1, s[48:51], s93 offen offset:256 nt
    v_add_f32 v5, v20, v21
    v_add_f32 v5, v5, v22
    s_nop 1
    v_add_f32_dpp v5, v5, v5 quad_perm:[1,0,3,2] row_mask:0xf bank_mask:0xf
    s_nop 1
    v_add_f32_dpp v5, v5, v5 quad_perm:[2,3,0,1] row_mask:0xf bank_mask:0xf
    s_nop 1
    v_add_f32_dpp v5, v5, v5 row_half_mirror row_mask:0xf bank_mask:0xf
    v_cvt_pk_bf16_f32 v6, v4, v5
    v_lshlrev_b32 v4, 16, v6
    v_and_b32 v5, 0xffff0000, v6
    v_mul_f32 v4, s94, v4
    v_mul_f32 v5, s94, v5
    v_cvt_pk_bf16_f32 v32, v4, v5
    s_waitcnt vmcnt(21)
    v_dot2_f32_bf16 v20, v68, v8, 0
    v_dot2_f32_bf16 v21, v72, v12, 0
    v_dot2_f32_bf16 v22, v76, v16, 0
    v_dot2_f32_bf16 v20, v69, v9, v20
    v_dot2_f32_bf16 v21, v73, v13, v21
    v_dot2_f32_bf16 v22, v77, v17, v22
    v_dot2_f32_bf16 v20, v70, v10, v20
    v_dot2_f32_bf16 v21, v74, v14, v21
    v_dot2_f32_bf16 v22, v78, v18, v22
    v_dot2_f32_bf16 v20, v71, v11, v20
    v_dot2_f32_bf16 v21, v75, v15, v21
    v_dot2_f32_bf16 v22, v79, v19, v22
    s_mov_b32 s93, 110592
    buffer_load_dwordx4 v[68:71], v1, s[48:51], s93 offen offset:0 nt
    buffer_load_dwordx4 v[72:75], v1, s[48:51], s93 offen offset:128 nt
    buffer_load_dwordx4 v[76:79], v1, s[48:51], s93 offen offset:256 nt
    v_add_f32 v4, v20, v21
    v_add_f32 v4, v4, v22
    s_nop 1
    v_add_f32_dpp v4, v4, v4 quad_perm:[1,0,3,2] row_mask:0xf bank_mask:0xf
    s_nop 1
    v_add_f32_dpp v4, v4, v4 quad_perm:[2,3,0,1] row_mask:0xf bank_mask:0xf
    s_nop 1
    v_add_f32_dpp v4, v4, v4 row_half_mirror row_mask:0xf bank_mask:0xf
    s_waitcnt vmcnt(21)
    v_dot2_f32_bf16 v20, v80, v8, 0
    v_dot2_f32_bf16 v21, v84, v12, 0
    v_dot2_f32_bf16 v22, v88, v16, 0
    v_dot2_f32_bf16 v20, v81, v9, v20
    v_dot2_f32_bf16 v21, v85, v13, v21
    v_dot2_f32_bf16 v22, v89, v17, v22
    v_dot2_f32_bf16 v20, v82, v10, v20
    v_dot2_f32_bf16 v21, v86, v14, v21
    v_dot2_f32_bf16 v22, v90, v18, v22
    v_dot2_f32_bf16 v20, v83, v11, v20
    v_dot2_f32_bf16 v21, v87, v15, v21
    v_dot2_f32_bf16 v22, v91, v19, v22
    s_mov_b32 s93, 122880
    buffer_load_dwordx4 v[80:83], v1, s[48:51], s93 offen offset:0 nt
    buffer_load_dwordx4 v[84:87], v1, s[48:51], s93 offen offset:128 nt
    buffer_load_dwordx4 v[88:91], v1, s[48:51], s93 offen offset:256 nt
    v_add_f32 v5, v20, v21
    v_add_f32 v5, v5, v22
    s_nop 1
    v_add_f32_dpp v5, v5, v5 quad_perm:[1,0,3,2] row_mask:0xf bank_mask:0xf
    s_nop 1
    v_add_f32_dpp v5, v5, v5 quad_perm:[2,3,0,1] row_mask:0xf bank_mask:0xf
    s_nop 1
    v_add_f32_dpp v5, v5, v5 row_half_mirror row_mask:0xf bank_mask:0xf
    v_cvt_pk_bf16_f32 v6, v4, v5
    v_lshlrev_b32 v4, 16, v6
    v_and_b32 v5, 0xffff0000, v6
    v_mul_f32 v4, s94, v4
    v_mul_f32 v5, s94, v5
    v_cvt_pk_bf16_f32 v33, v4, v5
    s_waitcnt vmcnt(21)
    v_dot2_f32_bf16 v20, v92, v8, 0
    v_dot2_f32_bf16 v21, v96, v12, 0
    v_dot2_f32_bf16 v22, v100, v16, 0
    v_dot2_f32_bf16 v20, v93, v9, v20
    v_dot2_f32_bf16 v21, v97, v13, v21
    v_dot2_f32_bf16 v22, v101, v17, v22
    v_dot2_f32_bf16 v20, v94, v10, v20
    v_dot2_f32_bf16 v21, v98, v14, v21
    v_dot2_f32_bf16 v22, v102, v18, v22
    v_dot2_f32_bf16 v20, v95, v11, v20
    v_dot2_f32_bf16 v21, v99, v15, v21
    v_dot2_f32_bf16 v22, v103, v19, v22
    s_mov_b32 s93, 135168
    buffer_load_dwordx4 v[92:95], v1, s[48:51], s93 offen offset:0 nt
    buffer_load_dwordx4 v[96:99], v1, s[48:51], s93 offen offset:128 nt
    buffer_load_dwordx4 v[100:103], v1, s[48:51], s93 offen offset:256 nt
    v_add_f32 v4, v20, v21
    v_add_f32 v4, v4, v22
    s_nop 1
    v_add_f32_dpp v4, v4, v4 quad_perm:[1,0,3,2] row_mask:0xf bank_mask:0xf
    s_nop 1
    v_add_f32_dpp v4, v4, v4 quad_perm:[2,3,0,1] row_mask:0xf bank_mask:0xf
    s_nop 1
    v_add_f32_dpp v4, v4, v4 row_half_mirror row_mask:0xf bank_mask:0xf
    s_waitcnt vmcnt(21)
    v_dot2_f32_bf16 v20, v104, v8, 0
    v_dot2_f32_bf16 v21, v108, v12, 0
    v_dot2_f32_bf16 v22, v112, v16, 0
    v_dot2_f32_bf16 v20, v105, v9, v20
    v_dot2_f32_bf16 v21, v109, v13, v21
    v_dot2_f32_bf16 v22, v113, v17, v22
    v_dot2_f32_bf16 v20, v106, v10, v20
    v_dot2_f32_bf16 v21, v110, v14, v21
    v_dot2_f32_bf16 v22, v114, v18, v22
    v_dot2_f32_bf16 v20, v107, v11, v20
    v_dot2_f32_bf16 v21, v111, v15, v21
    v_dot2_f32_bf16 v22, v115, v19, v22
    s_mov_b32 s93, 147456
    buffer_load_dwordx4 v[104:107], v1, s[48:51], s93 offen offset:0 nt
    buffer_load_dwordx4 v[108:111], v1, s[48:51], s93 offen offset:128 nt
    buffer_load_dwordx4 v[112:115], v1, s[48:51], s93 offen offset:256 nt
    v_add_f32 v5, v20, v21
    v_add_f32 v5, v5, v22
    s_nop 1
    v_add_f32_dpp v5, v5, v5 quad_perm:[1,0,3,2] row_mask:0xf bank_mask:0xf
    s_nop 1
    v_add_f32_dpp v5, v5, v5 quad_perm:[2,3,0,1] row_mask:0xf bank_mask:0xf
    s_nop 1
    v_add_f32_dpp v5, v5, v5 row_half_mirror row_mask:0xf bank_mask:0xf
    v_cvt_pk_bf16_f32 v6, v4, v5
    v_lshlrev_b32 v4, 16, v6
    v_and_b32 v5, 0xffff0000, v6
    v_mul_f32 v4, s94, v4
    v_mul_f32 v5, s94, v5
    v_cvt_pk_bf16_f32 v34, v4, v5
    s_waitcnt vmcnt(21)
    v_dot2_f32_bf16 v20, v116, v8, 0
    v_dot2_f32_bf16 v21, v120, v12, 0
    v_dot2_f32_bf16 v22, v124, v16, 0
    v_dot2_f32_bf16 v20, v117, v9, v20
    v_dot2_f32_bf16 v21, v121, v13, v21
    v_dot2_f32_bf16 v22, v125, v17, v22
    v_dot2_f32_bf16 v20, v118, v10, v20
    v_dot2_f32_bf16 v21, v122, v14, v21
    v_dot2_f32_bf16 v22, v126, v18, v22
    v_dot2_f32_bf16 v20, v119, v11, v20
    v_dot2_f32_bf16 v21, v123, v15, v21
    v_dot2_f32_bf16 v22, v127, v19, v22
    s_mov_b32 s93, 159744
    buffer_load_dwordx4 v[116:119], v1, s[48:51], s93 offen offset:0 nt
    buffer_load_dwordx4 v[120:123], v1, s[48:51], s93 offen offset:128 nt
    buffer_load_dwordx4 v[124:127], v1, s[48:51], s93 offen offset:256 nt
    v_add_f32 v4, v20, v21
    v_add_f32 v4, v4, v22
    s_nop 1
    v_add_f32_dpp v4, v4, v4 quad_perm:[1,0,3,2] row_mask:0xf bank_mask:0xf
    s_nop 1
    v_add_f32_dpp v4, v4, v4 quad_perm:[2,3,0,1] row_mask:0xf bank_mask:0xf
    s_nop 1
    v_add_f32_dpp v4, v4, v4 row_half_mirror row_mask:0xf bank_mask:0xf
    s_waitcnt vmcnt(18)
    v_lshlrev_b32 v2, 4, v0
    ds_write_b128 v2, v[24:27] offset:25856
    ds_write_b128 v2, v[28:31] offset:42240
    ds_write_b128 v2, v[40:43] offset:58624
    v_dot2_f32_bf16 v20, v44, v8, 0
    v_dot2_f32_bf16 v21, v48, v12, 0
    v_dot2_f32_bf16 v22, v52, v16, 0
    v_dot2_f32_bf16 v20, v45, v9, v20
    v_dot2_f32_bf16 v21, v49, v13, v21
    v_dot2_f32_bf16 v22, v53, v17, v22
    v_dot2_f32_bf16 v20, v46, v10, v20
    v_dot2_f32_bf16 v21, v50, v14, v21
    v_dot2_f32_bf16 v22, v54, v18, v22
    v_dot2_f32_bf16 v20, v47, v11, v20
    v_dot2_f32_bf16 v21, v51, v15, v21
    v_dot2_f32_bf16 v22, v55, v19, v22
    s_mov_b32 s93, 172032
    buffer_load_dwordx4 v[44:47], v1, s[48:51], s93 offen offset:0 nt
    buffer_load_dwordx4 v[48:51], v1, s[48:51], s93 offen offset:128 nt
    buffer_load_dwordx4 v[52:55], v1, s[48:51], s93 offen offset:256 nt
    v_add_f32 v5, v20, v21
    v_add_f32 v5, v5, v22
    s_nop 1
    v_add_f32_dpp v5, v5, v5 quad_perm:[1,0,3,2] row_mask:0xf bank_mask:0xf
    s_nop 1
    v_add_f32_dpp v5, v5, v5 quad_perm:[2,3,0,1] row_mask:0xf bank_mask:0xf
    s_nop 1
    v_add_f32_dpp v5, v5, v5 row_half_mirror row_mask:0xf bank_mask:0xf
    v_cvt_pk_bf16_f32 v6, v4, v5
    v_lshlrev_b32 v4, 16, v6
    v_and_b32 v5, 0xffff0000, v6
    v_mul_f32 v4, s94, v4
    v_mul_f32 v5, s94, v5
    v_cvt_pk_bf16_f32 v35, v4, v5
    s_waitcnt vmcnt(18)
    v_dot2_f32_bf16 v20, v56, v8, 0
    v_dot2_f32_bf16 v21, v60, v12, 0
    v_dot2_f32_bf16 v22, v64, v16, 0
    v_dot2_f32_bf16 v20, v57, v9, v20
    v_dot2_f32_bf16 v21, v61, v13, v21
    v_dot2_f32_bf16 v22, v65, v17, v22
    v_dot2_f32_bf16 v20, v58, v10, v20
    v_dot2_f32_bf16 v21, v62, v14, v21
    v_dot2_f32_bf16 v22, v66, v18, v22
    v_dot2_f32_bf16 v20, v59, v11, v20
    v_dot2_f32_bf16 v21, v63, v15, v21
    v_dot2_f32_bf16 v22, v67, v19, v22
    s_mov_b32 s93, 184320
    buffer_load_dwordx4 v[56:59], v1, s[48:51], s93 offen offset:0 nt
    buffer_load_dwordx4 v[60:63], v1, s[48:51], s93 offen offset:128 nt
    buffer_load_dwordx4 v[64:67], v1, s[48:51], s93 offen offset:256 nt
    v_add_f32 v4, v20, v21
    v_add_f32 v4, v4, v22
    s_nop 1
    v_add_f32_dpp v4, v4, v4 quad_perm:[1,0,3,2] row_mask:0xf bank_mask:0xf
    s_nop 1
    v_add_f32_dpp v4, v4, v4 quad_perm:[2,3,0,1] row_mask:0xf bank_mask:0xf
    s_nop 1
    v_add_f32_dpp v4, v4, v4 row_half_mirror row_mask:0xf bank_mask:0xf
    s_waitcnt vmcnt(18)
    v_dot2_f32_bf16 v20, v68, v8, 0
    v_dot2_f32_bf16 v21, v72, v12, 0
    v_dot2_f32_bf16 v22, v76, v16, 0
    v_dot2_f32_bf16 v20, v69, v9, v20
    v_dot2_f32_bf16 v21, v73, v13, v21
    v_dot2_f32_bf16 v22, v77, v17, v22
    v_dot2_f32_bf16 v20, v70, v10, v20
    v_dot2_f32_bf16 v21, v74, v14, v21
    v_dot2_f32_bf16 v22, v78, v18, v22
    v_dot2_f32_bf16 v20, v71, v11, v20
    v_dot2_f32_bf16 v21, v75, v15, v21
    v_dot2_f32_bf16 v22, v79, v19, v22
    s_mov_b32 s93, 0
    buffer_load_dwordx4 v[68:71], v1, s[52:55], s93 offen offset:0 nt
    buffer_load_dwordx4 v[72:75], v1, s[52:55], s93 offen offset:128 nt
    buffer_load_dwordx4 v[76:79], v1, s[52:55], s93 offen offset:256 nt
    v_add_f32 v5, v20, v21
    v_add_f32 v5, v5, v22
    s_nop 1
    v_add_f32_dpp v5, v5, v5 quad_perm:[1,0,3,2] row_mask:0xf bank_mask:0xf
    s_nop 1
    v_add_f32_dpp v5, v5, v5 quad_perm:[2,3,0,1] row_mask:0xf bank_mask:0xf
    s_nop 1
    v_add_f32_dpp v5, v5, v5 row_half_mirror row_mask:0xf bank_mask:0xf
    v_cvt_pk_bf16_f32 v6, v4, v5
    v_lshlrev_b32 v4, 16, v6
    v_and_b32 v5, 0xffff0000, v6
    v_mul_f32 v4, s94, v4
    v_mul_f32 v5, s94, v5
    v_cvt_pk_bf16_f32 v36, v4, v5
    s_waitcnt vmcnt(18)
    v_dot2_f32_bf16 v20, v80, v8, 0
    v_dot2_f32_bf16 v21, v84, v12, 0
    v_dot2_f32_bf16 v22, v88, v16, 0
    v_dot2_f32_bf16 v20, v81, v9, v20
    v_dot2_f32_bf16 v21, v85, v13, v21
    v_dot2_f32_bf16 v22, v89, v17, v22
    v_dot2_f32_bf16 v20, v82, v10, v20
    v_dot2_f32_bf16 v21, v86, v14, v21
    v_dot2_f32_bf16 v22, v90, v18, v22
    v_dot2_f32_bf16 v20, v83, v11, v20
    v_dot2_f32_bf16 v21, v87, v15, v21
    v_dot2_f32_bf16 v22, v91, v19, v22
    s_mov_b32 s93, 12288
    buffer_load_dwordx4 v[80:83], v1, s[52:55], s93 offen offset:0 nt
    buffer_load_dwordx4 v[84:87], v1, s[52:55], s93 offen offset:128 nt
    buffer_load_dwordx4 v[88:91], v1, s[52:55], s93 offen offset:256 nt
    v_add_f32 v4, v20, v21
    v_add_f32 v4, v4, v22
    s_nop 1
    v_add_f32_dpp v4, v4, v4 quad_perm:[1,0,3,2] row_mask:0xf bank_mask:0xf
    s_nop 1
    v_add_f32_dpp v4, v4, v4 quad_perm:[2,3,0,1] row_mask:0xf bank_mask:0xf
    s_nop 1
    v_add_f32_dpp v4, v4, v4 row_half_mirror row_mask:0xf bank_mask:0xf
    s_waitcnt vmcnt(18)
    v_dot2_f32_bf16 v20, v92, v8, 0
    v_dot2_f32_bf16 v21, v96, v12, 0
    v_dot2_f32_bf16 v22, v100, v16, 0
    v_dot2_f32_bf16 v20, v93, v9, v20
    v_dot2_f32_bf16 v21, v97, v13, v21
    v_dot2_f32_bf16 v22, v101, v17, v22
    v_dot2_f32_bf16 v20, v94, v10, v20
    v_dot2_f32_bf16 v21, v98, v14, v21
    v_dot2_f32_bf16 v22, v102, v18, v22
    v_dot2_f32_bf16 v20, v95, v11, v20
    v_dot2_f32_bf16 v21, v99, v15, v21
    v_dot2_f32_bf16 v22, v103, v19, v22
    s_mov_b32 s93, 24576
    buffer_load_dwordx4 v[92:95], v1, s[52:55], s93 offen offset:0 nt
    buffer_load_dwordx4 v[96:99], v1, s[52:55], s93 offen offset:128 nt
    buffer_load_dwordx4 v[100:103], v1, s[52:55], s93 offen offset:256 nt
    v_add_f32 v5, v20, v21
    v_add_f32 v5, v5, v22
    s_nop 1
    v_add_f32_dpp v5, v5, v5 quad_perm:[1,0,3,2] row_mask:0xf bank_mask:0xf
    s_nop 1
    v_add_f32_dpp v5, v5, v5 quad_perm:[2,3,0,1] row_mask:0xf bank_mask:0xf
    s_nop 1
    v_add_f32_dpp v5, v5, v5 row_half_mirror row_mask:0xf bank_mask:0xf
    v_cvt_pk_bf16_f32 v6, v4, v5
    v_lshlrev_b32 v4, 16, v6
    v_and_b32 v5, 0xffff0000, v6
    v_mul_f32 v4, s94, v4
    v_mul_f32 v5, s94, v5
    v_cvt_pk_bf16_f32 v37, v4, v5
    s_waitcnt vmcnt(18)
    v_dot2_f32_bf16 v20, v104, v8, 0
    v_dot2_f32_bf16 v21, v108, v12, 0
    v_dot2_f32_bf16 v22, v112, v16, 0
    v_dot2_f32_bf16 v20, v105, v9, v20
    v_dot2_f32_bf16 v21, v109, v13, v21
    v_dot2_f32_bf16 v22, v113, v17, v22
    v_dot2_f32_bf16 v20, v106, v10, v20
    v_dot2_f32_bf16 v21, v110, v14, v21
    v_dot2_f32_bf16 v22, v114, v18, v22
    v_dot2_f32_bf16 v20, v107, v11, v20
    v_dot2_f32_bf16 v21, v111, v15, v21
    v_dot2_f32_bf16 v22, v115, v19, v22
    s_mov_b32 s93, 36864
    buffer_load_dwordx4 v[104:107], v1, s[52:55], s93 offen offset:0 nt
    buffer_load_dwordx4 v[108:111], v1, s[52:55], s93 offen offset:128 nt
    buffer_load_dwordx4 v[112:115], v1, s[52:55], s93 offen offset:256 nt
    v_add_f32 v4, v20, v21
    v_add_f32 v4, v4, v22
    s_nop 1
    v_add_f32_dpp v4, v4, v4 quad_perm:[1,0,3,2] row_mask:0xf bank_mask:0xf
    s_nop 1
    v_add_f32_dpp v4, v4, v4 quad_perm:[2,3,0,1] row_mask:0xf bank_mask:0xf
    s_nop 1
    v_add_f32_dpp v4, v4, v4 row_half_mirror row_mask:0xf bank_mask:0xf
    s_waitcnt vmcnt(18)
    v_dot2_f32_bf16 v20, v116, v8, 0
    v_dot2_f32_bf16 v21, v120, v12, 0
    v_dot2_f32_bf16 v22, v124, v16, 0
    v_dot2_f32_bf16 v20, v117, v9, v20
    v_dot2_f32_bf16 v21, v121, v13, v21
    v_dot2_f32_bf16 v22, v125, v17, v22
    v_dot2_f32_bf16 v20, v118, v10, v20
    v_dot2_f32_bf16 v21, v122, v14, v21
    v_dot2_f32_bf16 v22, v126, v18, v22
    v_dot2_f32_bf16 v20, v119, v11, v20
    v_dot2_f32_bf16 v21, v123, v15, v21
    v_dot2_f32_bf16 v22, v127, v19, v22
    s_mov_b32 s93, 49152
    buffer_load_dwordx4 v[116:119], v1, s[52:55], s93 offen offset:0 nt
    buffer_load_dwordx4 v[120:123], v1, s[52:55], s93 offen offset:128 nt
    buffer_load_dwordx4 v[124:127], v1, s[52:55], s93 offen offset:256 nt
    v_add_f32 v5, v20, v21
    v_add_f32 v5, v5, v22
    s_nop 1
    v_add_f32_dpp v5, v5, v5 quad_perm:[1,0,3,2] row_mask:0xf bank_mask:0xf
    s_nop 1
    v_add_f32_dpp v5, v5, v5 quad_perm:[2,3,0,1] row_mask:0xf bank_mask:0xf
    s_nop 1
    v_add_f32_dpp v5, v5, v5 row_half_mirror row_mask:0xf bank_mask:0xf
    v_cvt_pk_bf16_f32 v6, v4, v5
    v_lshlrev_b32 v4, 16, v6
    v_and_b32 v5, 0xffff0000, v6
    v_mul_f32 v4, s94, v4
    v_mul_f32 v5, s94, v5
    v_cvt_pk_bf16_f32 v38, v4, v5
    s_waitcnt vmcnt(18)
    v_dot2_f32_bf16 v20, v44, v8, 0
    v_dot2_f32_bf16 v21, v48, v12, 0
    v_dot2_f32_bf16 v22, v52, v16, 0
    v_dot2_f32_bf16 v20, v45, v9, v20
    v_dot2_f32_bf16 v21, v49, v13, v21
    v_dot2_f32_bf16 v22, v53, v17, v22
    v_dot2_f32_bf16 v20, v46, v10, v20
    v_dot2_f32_bf16 v21, v50, v14, v21
    v_dot2_f32_bf16 v22, v54, v18, v22
    v_dot2_f32_bf16 v20, v47, v11, v20
    v_dot2_f32_bf16 v21, v51, v15, v21
    v_dot2_f32_bf16 v22, v55, v19, v22
    s_mov_b32 s93, 61440
    buffer_load_dwordx4 v[44:47], v1, s[52:55], s93 offen offset:0 nt
    buffer_load_dwordx4 v[48:51], v1, s[52:55], s93 offen offset:128 nt
    buffer_load_dwordx4 v[52:55], v1, s[52:55], s93 offen offset:256 nt
    v_add_f32 v4, v20, v21
    v_add_f32 v4, v4, v22
    s_nop 1
    v_add_f32_dpp v4, v4, v4 quad_perm:[1,0,3,2] row_mask:0xf bank_mask:0xf
    s_nop 1
    v_add_f32_dpp v4, v4, v4 quad_perm:[2,3,0,1] row_mask:0xf bank_mask:0xf
    s_nop 1
    v_add_f32_dpp v4, v4, v4 row_half_mirror row_mask:0xf bank_mask:0xf
    s_waitcnt vmcnt(18)
    v_dot2_f32_bf16 v20, v56, v8, 0
    v_dot2_f32_bf16 v21, v60, v12, 0
    v_dot2_f32_bf16 v22, v64, v16, 0
    v_dot2_f32_bf16 v20, v57, v9, v20
    v_dot2_f32_bf16 v21, v61, v13, v21
    v_dot2_f32_bf16 v22, v65, v17, v22
    v_dot2_f32_bf16 v20, v58, v10, v20
    v_dot2_f32_bf16 v21, v62, v14, v21
    v_dot2_f32_bf16 v22, v66, v18, v22
    v_dot2_f32_bf16 v20, v59, v11, v20
    v_dot2_f32_bf16 v21, v63, v15, v21
    v_dot2_f32_bf16 v22, v67, v19, v22
    s_mov_b32 s93, 73728
    buffer_load_dwordx4 v[56:59], v1, s[52:55], s93 offen offset:0 nt
    buffer_load_dwordx4 v[60:63], v1, s[52:55], s93 offen offset:128 nt
    buffer_load_dwordx4 v[64:67], v1, s[52:55], s93 offen offset:256 nt
    v_add_f32 v5, v20, v21
    v_add_f32 v5, v5, v22
    s_nop 1
    v_add_f32_dpp v5, v5, v5 quad_perm:[1,0,3,2] row_mask:0xf bank_mask:0xf
    s_nop 1
    v_add_f32_dpp v5, v5, v5 quad_perm:[2,3,0,1] row_mask:0xf bank_mask:0xf
    s_nop 1
    v_add_f32_dpp v5, v5, v5 row_half_mirror row_mask:0xf bank_mask:0xf
    v_cvt_pk_bf16_f32 v6, v4, v5
    v_lshlrev_b32 v4, 16, v6
    v_and_b32 v5, 0xffff0000, v6
    v_mul_f32 v4, s94, v4
    v_mul_f32 v5, s94, v5
    v_cvt_pk_bf16_f32 v39, v4, v5
    v_lshlrev_b32 v8, 16, v32
    v_and_b32 v9, 0xffff0000, v32
    v_lshlrev_b32 v10, 16, v33
    v_and_b32 v11, 0xffff0000, v33
    v_lshlrev_b32 v12, 16, v34
    v_and_b32 v13, 0xffff0000, v34
    v_lshlrev_b32 v14, 16, v35
    v_and_b32 v15, 0xffff0000, v35
    v_lshlrev_b32 v16, 16, v36
    v_and_b32 v17, 0xffff0000, v36
    v_lshlrev_b32 v18, 16, v37
    v_and_b32 v19, 0xffff0000, v37
    v_lshlrev_b32 v20, 16, v38
    v_and_b32 v21, 0xffff0000, v38
    v_lshlrev_b32 v22, 16, v39
    v_and_b32 v23, 0xffff0000, v39
    v_max_f32 v4, v8, v9
    v_max3_f32 v4, v4, v10, v11
    v_max3_f32 v4, v4, v12, v13
    v_max3_f32 v4, v4, v14, v15
    v_max3_f32 v4, v4, v16, v17
    v_max3_f32 v4, v4, v18, v19
    v_max3_f32 v4, v4, v20, v21
    v_max3_f32 v4, v4, v22, v23
    s_nop 1
    v_max_f32_dpp v4, v4, v4 row_ror:8 row_mask:0xf bank_mask:0xf
    v_mov_b32 v5, v4
    s_nop 1
    v_permlane16_swap_b32 v4, v5
    s_nop 0
    v_max_f32 v4, v4, v5
    v_mov_b32 v5, v4
    s_nop 1
    v_permlane32_swap_b32 v4, v5
    s_nop 0
    v_max_f32 v4, v4, v5
    v_sub_f32 v6, v8, v4
    v_mul_f32 v6, s95, v6
    v_exp_f32 v24, v6
    v_sub_f32 v6, v9, v4
    v_mul_f32 v6, s95, v6
    v_exp_f32 v25, v6
    s_nop 0
    v_add_f32 v5, v24, v25
    v_sub_f32 v6, v10, v4
    v_mul_f32 v6, s95, v6
    v_exp_f32 v24, v6
    v_sub_f32 v6, v11, v4
    v_mul_f32 v6, s95, v6
    v_exp_f32 v25, v6
    v_add_f32 v5, v5, v24
    v_add_f32 v5, v5, v25
    v_sub_f32 v6, v12, v4
    v_mul_f32 v6, s95, v6
    v_exp_f32 v24, v6
    v_sub_f32 v6, v13, v4
    v_mul_f32 v6, s95, v6
    v_exp_f32 v25, v6
    v_add_f32 v5, v5, v24
    v_add_f32 v5, v5, v25
    v_sub_f32 v6, v14, v4
    v_mul_f32 v6, s95, v6
    v_exp_f32 v24, v6
    v_sub_f32 v6, v15, v4
    v_mul_f32 v6, s95, v6
    v_exp_f32 v25, v6
    v_add_f32 v5, v5, v24
    v_add_f32 v5, v5, v25
    v_sub_f32 v6, v16, v4
    v_mul_f32 v6, s95, v6
    v_exp_f32 v24, v6
    v_sub_f32 v6, v17, v4
    v_mul_f32 v6, s95, v6
    v_exp_f32 v25, v6
    v_add_f32 v5, v5, v24
    v_add_f32 v5, v5, v25
    v_sub_f32 v6, v18, v4
    v_mul_f32 v6, s95, v6
    v_exp_f32 v24, v6
    v_sub_f32 v6, v19, v4
    v_mul_f32 v6, s95, v6
    v_exp_f32 v25, v6
    v_add_f32 v5, v5, v24
    v_add_f32 v5, v5, v25
    v_sub_f32 v6, v20, v4
    v_mul_f32 v6, s95, v6
    v_exp_f32 v24, v6
    v_sub_f32 v6, v21, v4
    v_mul_f32 v6, s95, v6
    v_exp_f32 v25, v6
    v_add_f32 v5, v5, v24
    v_add_f32 v5, v5, v25
    v_sub_f32 v6, v22, v4
    v_mul_f32 v6, s95, v6
    v_exp_f32 v24, v6
    v_sub_f32 v6, v23, v4
    v_mul_f32 v6, s95, v6
    v_exp_f32 v25, v6
    v_add_f32 v5, v5, v24
    v_add_f32 v5, v5, v25
    s_nop 1
    v_add_f32_dpp v5, v5, v5 row_ror:8 row_mask:0xf bank_mask:0xf
    v_mov_b32 v6, v5
    s_nop 1
    v_permlane16_swap_b32 v5, v6
    s_nop 0
    v_add_f32 v5, v5, v6
    v_mov_b32 v6, v5
    s_nop 1
    v_permlane32_swap_b32 v5, v6
    s_nop 0
    v_add_f32 v5, v5, v6
    v_lshrrev_b32 v7, 6, v0
    v_lshlrev_b32 v6, 3, v7
    s_mov_b32 exec_lo, 0x1
    s_mov_b32 exec_hi, 0x0
    ds_write_b64 v6, v[4:5] offset:7424
    s_mov_b64 exec, -1
    s_waitcnt lgkmcnt(0)
    s_barrier
    s_cmp_lg_u32 s84, 0
    s_cbranch_scc1 L_s2_done
    v_and_b32 v6, 15, v3
    v_lshlrev_b32 v6, 3, v6
    ds_read_b64 v[4:5], v6 offset:7424
    s_waitcnt lgkmcnt(0)
    v_mov_b32 v24, v4
    s_nop 1
    v_max_f32_dpp v24, v24, v24 quad_perm:[1,0,3,2] row_mask:0xf bank_mask:0xf
    s_nop 1
    v_max_f32_dpp v24, v24, v24 quad_perm:[2,3,0,1] row_mask:0xf bank_mask:0xf
    s_nop 1
    v_max_f32_dpp v24, v24, v24 row_half_mirror row_mask:0xf bank_mask:0xf
    s_nop 1
    v_max_f32_dpp v24, v24, v24 row_mirror row_mask:0xf bank_mask:0xf
    v_sub_f32 v6, v4, v24
    v_mul_f32 v6, s95, v6
    v_exp_f32 v6, v6
    s_nop 0
    v_mul_f32 v25, v5, v6
    s_nop 1
    v_add_f32_dpp v25, v25, v25 quad_perm:[1,0,3,2] row_mask:0xf bank_mask:0xf
    s_nop 1
    v_add_f32_dpp v25, v25, v25 quad_perm:[2,3,0,1] row_mask:0xf bank_mask:0xf
    s_nop 1
    v_add_f32_dpp v25, v25, v25 row_half_mirror row_mask:0xf bank_mask:0xf
    s_nop 1
    v_add_f32_dpp v25, v25, v25 row_mirror row_mask:0xf bank_mask:0xf
    v_mov_b32 v26, s42
    v_mov_b32 v27, s43
    s_lshl_b32 s4, s88, 6
    s_add_u32 s4, s4, 65536
    s_lshl_b32 s5, s89, 4
    v_mov_b32 v6, s5
    s_mov_b32 exec_lo, 0x1
    s_mov_b32 exec_hi, 0x0
    buffer_store_dwordx4 v[24:27], v6, s[64:67], s4 offen sc1
    s_mov_b32 exec_lo, 0xf
    s_mov_b32 exec_hi, 0x0
    v_lshlrev_b32 v6, 4, v3
    s_mov_b32 s92, 0
L_poll_11:
    buffer_load_dwordx4 v[28:31], v6, s[64:67], s4 offen sc1
    s_waitcnt vmcnt(0)
    v_cmp_ne_u64 vcc, s[42:43], v[30:31]
    s_cbranch_vccz L_pdone_12
    s_add_u32 s92, s92, 1
    s_cmp_lt_u32 s92, 65536
    s_cbranch_scc0 L_pdone_12
    s_sleep 1
    s_branch L_poll_11
L_pdone_12:
    v_mov_b32 v24, v28
    s_nop 1
    v_max_f32_dpp v24, v24, v24 quad_perm:[1,0,3,2] row_mask:0xf bank_mask:0xf
    s_nop 1
    v_max_f32_dpp v24, v24, v24 quad_perm:[2,3,0,1] row_mask:0xf bank_mask:0xf
    v_sub_f32 v6, v28, v24
    v_mul_f32 v6, s95, v6
    v_exp_f32 v6, v6
    s_nop 0
    v_mul_f32 v25, v29, v6
    s_nop 1
    v_add_f32_dpp v25, v25, v25 quad_perm:[1,0,3,2] row_mask:0xf bank_mask:0xf
    s_nop 1
    v_add_f32_dpp v25, v25, v25 quad_perm:[2,3,0,1] row_mask:0xf bank_mask:0xf
    v_rcp_f32 v25, v25
    v_mov_b32 v6, 0
    s_mov_b32 exec_lo, 0x1
    s_mov_b32 exec_hi, 0x0
    ds_write_b64 v6, v[24:25] offset:7296
    s_mov_b64 exec, -1
    s_waitcnt lgkmcnt(0)
L_s2_done:
    s_barrier
    v_mov_b32 v6, 0
    ds_read_b64 v[4:5], v6 offset:7296
    s_waitcnt lgkmcnt(0)
    v_sub_f32 v6, v8, v4
    v_sub_f32 v7, v9, v4
    v_mul_f32 v6, s95, v6
    v_mul_f32 v7, s95, v7
    v_exp_f32 v6, v6
    v_exp_f32 v7, v7
    s_nop 0
    v_mul_f32 v6, v6, v5
    v_mul_f32 v7, v7, v5
    v_cvt_pk_bf16_f32 v32, v6, v7
    v_sub_f32 v6, v10, v4
    v_sub_f32 v7, v11, v4
    v_mul_f32 v6, s95, v6
    v_mul_f32 v7, s95, v7
    v_exp_f32 v6, v6
    v_exp_f32 v7, v7
    s_nop 0
    v_mul_f32 v6, v6, v5
    v_mul_f32 v7, v7, v5
    v_cvt_pk_bf16_f32 v33, v6, v7
    v_sub_f32 v6, v12, v4
    v_sub_f32 v7, v13, v4
    v_mul_f32 v6, s95, v6
    v_mul_f32 v7, s95, v7
    v_exp_f32 v6, v6
    v_exp_f32 v7, v7
    s_nop 0
    v_mul_f32 v6, v6, v5
    v_mul_f32 v7, v7, v5
    v_cvt_pk_bf16_f32 v34, v6, v7
    v_sub_f32 v6, v14, v4
    v_sub_f32 v7, v15, v4
    v_mul_f32 v6, s95, v6
    v_mul_f32 v7, s95, v7
    v_exp_f32 v6, v6
    v_exp_f32 v7, v7
    s_nop 0
    v_mul_f32 v6, v6, v5
    v_mul_f32 v7, v7, v5
    v_cvt_pk_bf16_f32 v35, v6, v7
    v_sub_f32 v6, v16, v4
    v_sub_f32 v7, v17, v4
    v_mul_f32 v6, s95, v6
    v_mul_f32 v7, s95, v7
    v_exp_f32 v6, v6
    v_exp_f32 v7, v7
    s_nop 0
    v_mul_f32 v6, v6, v5
    v_mul_f32 v7, v7, v5
    v_cvt_pk_bf16_f32 v36, v6, v7
    v_sub_f32 v6, v18, v4
    v_sub_f32 v7, v19, v4
    v_mul_f32 v6, s95, v6
    v_mul_f32 v7, s95, v7
    v_exp_f32 v6, v6
    v_exp_f32 v7, v7
    s_nop 0
    v_mul_f32 v6, v6, v5
    v_mul_f32 v7, v7, v5
    v_cvt_pk_bf16_f32 v37, v6, v7
    v_sub_f32 v6, v20, v4
    v_sub_f32 v7, v21, v4
    v_mul_f32 v6, s95, v6
    v_mul_f32 v7, s95, v7
    v_exp_f32 v6, v6
    v_exp_f32 v7, v7
    s_nop 0
    v_mul_f32 v6, v6, v5
    v_mul_f32 v7, v7, v5
    v_cvt_pk_bf16_f32 v38, v6, v7
    v_sub_f32 v6, v22, v4
    v_sub_f32 v7, v23, v4
    v_mul_f32 v6, s95, v6
    v_mul_f32 v7, s95, v7
    v_exp_f32 v6, v6
    v_exp_f32 v7, v7
    s_nop 0
    v_mul_f32 v6, v6, v5
    v_mul_f32 v7, v7, v5
    v_cvt_pk_bf16_f32 v39, v6, v7
    v_and_b32 v5, 0xffff, v32
    v_lshlrev_b32 v6, 16, v32
    s_waitcnt vmcnt(18)
    v_dot2_f32_bf16 v8, v68, v5, 0
    v_dot2_f32_bf16 v9, v68, v6, 0
    v_dot2_f32_bf16 v10, v69, v5, 0
    v_dot2_f32_bf16 v11, v69, v6, 0
    v_dot2_f32_bf16 v12, v70, v5, 0
    v_dot2_f32_bf16 v13, v70, v6, 0
    v_dot2_f32_bf16 v14, v71, v5, 0
    v_dot2_f32_bf16 v15, v71, v6, 0
    v_dot2_f32_bf16 v16, v72, v5, 0
    v_dot2_f32_bf16 v17, v72, v6, 0
    v_dot2_f32_bf16 v18, v73, v5, 0
    v_dot2_f32_bf16 v19, v73, v6, 0
    v_dot2_f32_bf16 v20, v74, v5, 0
    v_dot2_f32_bf16 v21, v74, v6, 0
    v_dot2_f32_bf16 v22, v75, v5, 0
    v_dot2_f32_bf16 v23, v75, v6, 0
    v_dot2_f32_bf16 v24, v76, v5, 0
    v_dot2_f32_bf16 v25, v76, v6, 0
    v_dot2_f32_bf16 v26, v77, v5, 0
    v_dot2_f32_bf16 v27, v77, v6, 0
    v_dot2_f32_bf16 v28, v78, v5, 0
    v_dot2_f32_bf16 v29, v78, v6, 0
    v_dot2_f32_bf16 v30, v79, v5, 0
    v_dot2_f32_bf16 v31, v79, v6, 0
    s_mov_b32 s93, 86016
    buffer_load_dwordx4 v[68:71], v1, s[52:55], s93 offen offset:0 nt
    buffer_load_dwordx4 v[72:75], v1, s[52:55], s93 offen offset:128 nt
    buffer_load_dwordx4 v[76:79], v1, s[52:55], s93 offen offset:256 nt
    v_lshrrev_b32 v5, 16, v32
    v_and_b32 v6, 0xffff0000, v32
    s_waitcnt vmcnt(18)
    v_dot2_f32_bf16 v8, v80, v5, v8
    v_dot2_f32_bf16 v9, v80, v6, v9
    v_dot2_f32_bf16 v10, v81, v5, v10
    v_dot2_f32_bf16 v11, v81, v6, v11
    v_dot2_f32_bf16 v12, v82, v5, v12
    v_dot2_f32_bf16 v13, v82, v6, v13
    v_dot2_f32_bf16 v14, v83, v5, v14
    v_dot2_f32_bf16 v15, v83, v6, v15
    v_dot2_f32_bf16 v16, v84, v5, v16
    v_dot2_f32_bf16 v17, v84, v6, v17
    v_dot2_f32_bf16 v18, v85, v5, v18
    v_dot2_f32_bf16 v19, v85, v6, v19
    v_dot2_f32_bf16 v20, v86, v5, v20
    v_dot2_f32_bf16 v21, v86, v6, v21
    v_dot2_f32_bf16 v22, v87, v5, v22
    v_dot2_f32_bf16 v23, v87, v6, v23
    v_dot2_f32_bf16 v24, v88, v5, v24
    v_dot2_f32_bf16 v25, v88, v6, v25
    v_dot2_f32_bf16 v26, v89, v5, v26
    v_dot2_f32_bf16 v27, v89, v6, v27
    v_dot2_f32_bf16 v28, v90, v5, v28
    v_dot2_f32_bf16 v29, v90, v6, v29
    v_dot2_f32_bf16 v30, v91, v5, v30
    v_dot2_f32_bf16 v31, v91, v6, v31
    s_mov_b32 s93, 98304
    buffer_load_dwordx4 v[80:83], v1, s[52:55], s93 offen offset:0 nt
    buffer_load_dwordx4 v[84:87], v1, s[52:55], s93 offen offset:128 nt
    buffer_load_dwordx4 v[88:91], v1, s[52:55], s93 offen offset:256 nt
    v_and_b32 v5, 0xffff, v33
    v_lshlrev_b32 v6, 16, v33
    s_waitcnt vmcnt(18)
    v_dot2_f32_bf16 v8, v92, v5, v8
    v_dot2_f32_bf16 v9, v92, v6, v9
    v_dot2_f32_bf16 v10, v93, v5, v10
    v_dot2_f32_bf16 v11, v93, v6, v11
    v_dot2_f32_bf16 v12, v94, v5, v12
    v_dot2_f32_bf16 v13, v94, v6, v13
    v_dot2_f32_bf16 v14, v95, v5, v14
    v_dot2_f32_bf16 v15, v95, v6, v15
    v_dot2_f32_bf16 v16, v96, v5, v16
    v_dot2_f32_bf16 v17, v96, v6, v17
    v_dot2_f32_bf16 v18, v97, v5, v18
    v_dot2_f32_bf16 v19, v97, v6, v19
    v_dot2_f32_bf16 v20, v98, v5, v20
    v_dot2_f32_bf16 v21, v98, v6, v21
    v_dot2_f32_bf16 v22, v99, v5, v22
    v_dot2_f32_bf16 v23, v99, v6, v23
    v_dot2_f32_bf16 v24, v100, v5, v24
    v_dot2_f32_bf16 v25, v100, v6, v25
    v_dot2_f32_bf16 v26, v101, v5, v26
    v_dot2_f32_bf16 v27, v101, v6, v27
    v_dot2_f32_bf16 v28, v102, v5, v28
    v_dot2_f32_bf16 v29, v102, v6, v29
    v_dot2_f32_bf16 v30, v103, v5, v30
    v_dot2_f32_bf16 v31, v103, v6, v31
    s_mov_b32 s93, 110592
    buffer_load_dwordx4 v[92:95], v1, s[52:55], s93 offen offset:0 nt
    buffer_load_dwordx4 v[96:99], v1, s[52:55], s93 offen offset:128 nt
    buffer_load_dwordx4 v[100:103], v1, s[52:55], s93 offen offset:256 nt
    v_lshrrev_b32 v5, 16, v33
    v_and_b32 v6, 0xffff0000, v33
    s_waitcnt vmcnt(18)
    v_dot2_f32_bf16 v8, v104, v5, v8
    v_dot2_f32_bf16 v9, v104, v6, v9
    v_dot2_f32_bf16 v10, v105, v5, v10
    v_dot2_f32_bf16 v11, v105, v6, v11
    v_dot2_f32_bf16 v12, v106, v5, v12
    v_dot2_f32_bf16 v13, v106, v6, v13
    v_dot2_f32_bf16 v14, v107, v5, v14
    v_dot2_f32_bf16 v15, v107, v6, v15
    v_dot2_f32_bf16 v16, v108, v5, v16
    v_dot2_f32_bf16 v17, v108, v6, v17
    v_dot2_f32_bf16 v18, v109, v5, v18
    v_dot2_f32_bf16 v19, v109, v6, v19
    v_dot2_f32_bf16 v20, v110, v5, v20
    v_dot2_f32_bf16 v21, v110, v6, v21
    v_dot2_f32_bf16 v22, v111, v5, v22
    v_dot2_f32_bf16 v23, v111, v6, v23
    v_dot2_f32_bf16 v24, v112, v5, v24
    v_dot2_f32_bf16 v25, v112, v6, v25
    v_dot2_f32_bf16 v26, v113, v5, v26
    v_dot2_f32_bf16 v27, v113, v6, v27
    v_dot2_f32_bf16 v28, v114, v5, v28
    v_dot2_f32_bf16 v29, v114, v6, v29
    v_dot2_f32_bf16 v30, v115, v5, v30
    v_dot2_f32_bf16 v31, v115, v6, v31
    s_mov_b32 s93, 122880
    buffer_load_dwordx4 v[104:107], v1, s[52:55], s93 offen offset:0 nt
    buffer_load_dwordx4 v[108:111], v1, s[52:55], s93 offen offset:128 nt
    buffer_load_dwordx4 v[112:115], v1, s[52:55], s93 offen offset:256 nt
    v_and_b32 v5, 0xffff, v34
    v_lshlrev_b32 v6, 16, v34
    s_waitcnt vmcnt(18)
    v_dot2_f32_bf16 v8, v116, v5, v8
    v_dot2_f32_bf16 v9, v116, v6, v9
    v_dot2_f32_bf16 v10, v117, v5, v10
    v_dot2_f32_bf16 v11, v117, v6, v11
    v_dot2_f32_bf16 v12, v118, v5, v12
    v_dot2_f32_bf16 v13, v118, v6, v13
    v_dot2_f32_bf16 v14, v119, v5, v14
    v_dot2_f32_bf16 v15, v119, v6, v15
    v_dot2_f32_bf16 v16, v120, v5, v16
    v_dot2_f32_bf16 v17, v120, v6, v17
    v_dot2_f32_bf16 v18, v121, v5, v18
    v_dot2_f32_bf16 v19, v121, v6, v19
    v_dot2_f32_bf16 v20, v122, v5, v20
    v_dot2_f32_bf16 v21, v122, v6, v21
    v_dot2_f32_bf16 v22, v123, v5, v22
    v_dot2_f32_bf16 v23, v123, v6, v23
    v_dot2_f32_bf16 v24, v124, v5, v24
    v_dot2_f32_bf16 v25, v124, v6, v25
    v_dot2_f32_bf16 v26, v125, v5, v26
    v_dot2_f32_bf16 v27, v125, v6, v27
    v_dot2_f32_bf16 v28, v126, v5, v28
    v_dot2_f32_bf16 v29, v126, v6, v29
    v_dot2_f32_bf16 v30, v127, v5, v30
    v_dot2_f32_bf16 v31, v127, v6, v31
    s_mov_b32 s93, 135168
    buffer_load_dwordx4 v[116:119], v1, s[52:55], s93 offen offset:0 nt
    buffer_load_dwordx4 v[120:123], v1, s[52:55], s93 offen offset:128 nt
    buffer_load_dwordx4 v[124:127], v1, s[52:55], s93 offen offset:256 nt
    v_lshrrev_b32 v5, 16, v34
    v_and_b32 v6, 0xffff0000, v34
    s_waitcnt vmcnt(18)
    v_dot2_f32_bf16 v8, v44, v5, v8
    v_dot2_f32_bf16 v9, v44, v6, v9
    v_dot2_f32_bf16 v10, v45, v5, v10
    v_dot2_f32_bf16 v11, v45, v6, v11
    v_dot2_f32_bf16 v12, v46, v5, v12
    v_dot2_f32_bf16 v13, v46, v6, v13
    v_dot2_f32_bf16 v14, v47, v5, v14
    v_dot2_f32_bf16 v15, v47, v6, v15
    v_dot2_f32_bf16 v16, v48, v5, v16
    v_dot2_f32_bf16 v17, v48, v6, v17
    v_dot2_f32_bf16 v18, v49, v5, v18
    v_dot2_f32_bf16 v19, v49, v6, v19
    v_dot2_f32_bf16 v20, v50, v5, v20
    v_dot2_f32_bf16 v21, v50, v6, v21
    v_dot2_f32_bf16 v22, v51, v5, v22
    v_dot2_f32_bf16 v23, v51, v6, v23
    v_dot2_f32_bf16 v24, v52, v5, v24
    v_dot2_f32_bf16 v25, v52, v6, v25
    v_dot2_f32_bf16 v26, v53, v5, v26
    v_dot2_f32_bf16 v27, v53, v6, v27
    v_dot2_f32_bf16 v28, v54, v5, v28
    v_dot2_f32_bf16 v29, v54, v6, v29
    v_dot2_f32_bf16 v30, v55, v5, v30
    v_dot2_f32_bf16 v31, v55, v6, v31
    s_mov_b32 s93, 147456
    buffer_load_dwordx4 v[44:47], v1, s[52:55], s93 offen offset:0 nt
    buffer_load_dwordx4 v[48:51], v1, s[52:55], s93 offen offset:128 nt
    buffer_load_dwordx4 v[52:55], v1, s[52:55], s93 offen offset:256 nt
    v_and_b32 v5, 0xffff, v35
    v_lshlrev_b32 v6, 16, v35
    s_waitcnt vmcnt(18)
    v_dot2_f32_bf16 v8, v56, v5, v8
    v_dot2_f32_bf16 v9, v56, v6, v9
    v_dot2_f32_bf16 v10, v57, v5, v10
    v_dot2_f32_bf16 v11, v57, v6, v11
    v_dot2_f32_bf16 v12, v58, v5, v12
    v_dot2_f32_bf16 v13, v58, v6, v13
    v_dot2_f32_bf16 v14, v59, v5, v14
    v_dot2_f32_bf16 v15, v59, v6, v15
    v_dot2_f32_bf16 v16, v60, v5, v16
    v_dot2_f32_bf16 v17, v60, v6, v17
    v_dot2_f32_bf16 v18, v61, v5, v18
    v_dot2_f32_bf16 v19, v61, v6, v19
    v_dot2_f32_bf16 v20, v62, v5, v20
    v_dot2_f32_bf16 v21, v62, v6, v21
    v_dot2_f32_bf16 v22, v63, v5, v22
    v_dot2_f32_bf16 v23, v63, v6, v23
    v_dot2_f32_bf16 v24, v64, v5, v24
    v_dot2_f32_bf16 v25, v64, v6, v25
    v_dot2_f32_bf16 v26, v65, v5, v26
    v_dot2_f32_bf16 v27, v65, v6, v27
    v_dot2_f32_bf16 v28, v66, v5, v28
    v_dot2_f32_bf16 v29, v66, v6, v29
    v_dot2_f32_bf16 v30, v67, v5, v30
    v_dot2_f32_bf16 v31, v67, v6, v31
    s_mov_b32 s93, 159744
    buffer_load_dwordx4 v[56:59], v1, s[52:55], s93 offen offset:0 nt
    buffer_load_dwordx4 v[60:63], v1, s[52:55], s93 offen offset:128 nt
    buffer_load_dwordx4 v[64:67], v1, s[52:55], s93 offen offset:256 nt
    v_lshrrev_b32 v5, 16, v35
    v_and_b32 v6, 0xffff0000, v35
    s_waitcnt vmcnt(18)
    v_dot2_f32_bf16 v8, v68, v5, v8
    v_dot2_f32_bf16 v9, v68, v6, v9
    v_dot2_f32_bf16 v10, v69, v5, v10
    v_dot2_f32_bf16 v11, v69, v6, v11
    v_dot2_f32_bf16 v12, v70, v5, v12
    v_dot2_f32_bf16 v13, v70, v6, v13
    v_dot2_f32_bf16 v14, v71, v5, v14
    v_dot2_f32_bf16 v15, v71, v6, v15
    v_dot2_f32_bf16 v16, v72, v5, v16
    v_dot2_f32_bf16 v17, v72, v6, v17
    v_dot2_f32_bf16 v18, v73, v5, v18
    v_dot2_f32_bf16 v19, v73, v6, v19
    v_dot2_f32_bf16 v20, v74, v5, v20
    v_dot2_f32_bf16 v21, v74, v6, v21
    v_dot2_f32_bf16 v22, v75, v5, v22
    v_dot2_f32_bf16 v23, v75, v6, v23
    v_dot2_f32_bf16 v24, v76, v5, v24
    v_dot2_f32_bf16 v25, v76, v6, v25
    v_dot2_f32_bf16 v26, v77, v5, v26
    v_dot2_f32_bf16 v27, v77, v6, v27
    v_dot2_f32_bf16 v28, v78, v5, v28
    v_dot2_f32_bf16 v29, v78, v6, v29
    v_dot2_f32_bf16 v30, v79, v5, v30
    v_dot2_f32_bf16 v31, v79, v6, v31
    s_mov_b32 s93, 172032
    buffer_load_dwordx4 v[68:71], v1, s[52:55], s93 offen offset:0 nt
    buffer_load_dwordx4 v[72:75], v1, s[52:55], s93 offen offset:128 nt
    buffer_load_dwordx4 v[76:79], v1, s[52:55], s93 offen offset:256 nt
    v_and_b32 v5, 0xffff, v36
    v_lshlrev_b32 v6, 16, v36
    s_waitcnt vmcnt(18)
    v_dot2_f32_bf16 v8, v80, v5, v8
    v_dot2_f32_bf16 v9, v80, v6, v9
    v_dot2_f32_bf16 v10, v81, v5, v10
    v_dot2_f32_bf16 v11, v81, v6, v11
    v_dot2_f32_bf16 v12, v82, v5, v12
    v_dot2_f32_bf16 v13, v82, v6, v13
    v_dot2_f32_bf16 v14, v83, v5, v14
    v_dot2_f32_bf16 v15, v83, v6, v15
    v_dot2_f32_bf16 v16, v84, v5, v16
    v_dot2_f32_bf16 v17, v84, v6, v17
    v_dot2_f32_bf16 v18, v85, v5, v18
    v_dot2_f32_bf16 v19, v85, v6, v19
    v_dot2_f32_bf16 v20, v86, v5, v20
    v_dot2_f32_bf16 v21, v86, v6, v21
    v_dot2_f32_bf16 v22, v87, v5, v22
    v_dot2_f32_bf16 v23, v87, v6, v23
    v_dot2_f32_bf16 v24, v88, v5, v24
    v_dot2_f32_bf16 v25, v88, v6, v25
    v_dot2_f32_bf16 v26, v89, v5, v26
    v_dot2_f32_bf16 v27, v89, v6, v27
    v_dot2_f32_bf16 v28, v90, v5, v28
    v_dot2_f32_bf16 v29, v90, v6, v29
    v_dot2_f32_bf16 v30, v91, v5, v30
    v_dot2_f32_bf16 v31, v91, v6, v31
    s_mov_b32 s93, 184320
    buffer_load_dwordx4 v[80:83], v1, s[52:55], s93 offen offset:0 nt
    buffer_load_dwordx4 v[84:87], v1, s[52:55], s93 offen offset:128 nt
    buffer_load_dwordx4 v[88:91], v1, s[52:55], s93 offen offset:256 nt
    v_lshrrev_b32 v5, 16, v36
    v_and_b32 v6, 0xffff0000, v36
    s_waitcnt vmcnt(18)
    v_dot2_f32_bf16 v8, v92, v5, v8
    v_dot2_f32_bf16 v9, v92, v6, v9
    v_dot2_f32_bf16 v10, v93, v5, v10
    v_dot2_f32_bf16 v11, v93, v6, v11
    v_dot2_f32_bf16 v12, v94, v5, v12
    v_dot2_f32_bf16 v13, v94, v6, v13
    v_dot2_f32_bf16 v14, v95, v5, v14
    v_dot2_f32_bf16 v15, v95, v6, v15
    v_dot2_f32_bf16 v16, v96, v5, v16
    v_dot2_f32_bf16 v17, v96, v6, v17
    v_dot2_f32_bf16 v18, v97, v5, v18
    v_dot2_f32_bf16 v19, v97, v6, v19
    v_dot2_f32_bf16 v20, v98, v5, v20
    v_dot2_f32_bf16 v21, v98, v6, v21
    v_dot2_f32_bf16 v22, v99, v5, v22
    v_dot2_f32_bf16 v23, v99, v6, v23
    v_dot2_f32_bf16 v24, v100, v5, v24
    v_dot2_f32_bf16 v25, v100, v6, v25
    v_dot2_f32_bf16 v26, v101, v5, v26
    v_dot2_f32_bf16 v27, v101, v6, v27
    v_dot2_f32_bf16 v28, v102, v5, v28
    v_dot2_f32_bf16 v29, v102, v6, v29
    v_dot2_f32_bf16 v30, v103, v5, v30
    v_dot2_f32_bf16 v31, v103, v6, v31
    v_and_b32 v5, 0xffff, v37
    v_lshlrev_b32 v6, 16, v37
    s_waitcnt vmcnt(15)
    v_dot2_f32_bf16 v8, v104, v5, v8
    v_dot2_f32_bf16 v9, v104, v6, v9
    v_dot2_f32_bf16 v10, v105, v5, v10
    v_dot2_f32_bf16 v11, v105, v6, v11
    v_dot2_f32_bf16 v12, v106, v5, v12
    v_dot2_f32_bf16 v13, v106, v6, v13
    v_dot2_f32_bf16 v14, v107, v5, v14
    v_dot2_f32_bf16 v15, v107, v6, v15
    v_dot2_f32_bf16 v16, v108, v5, v16
    v_dot2_f32_bf16 v17, v108, v6, v17
    v_dot2_f32_bf16 v18, v109, v5, v18
    v_dot2_f32_bf16 v19, v109, v6, v19
    v_dot2_f32_bf16 v20, v110, v5, v20
    v_dot2_f32_bf16 v21, v110, v6, v21
    v_dot2_f32_bf16 v22, v111, v5, v22
    v_dot2_f32_bf16 v23, v111, v6, v23
    v_dot2_f32_bf16 v24, v112, v5, v24
    v_dot2_f32_bf16 v25, v112, v6, v25
    v_dot2_f32_bf16 v26, v113, v5, v26
    v_dot2_f32_bf16 v27, v113, v6, v27
    v_dot2_f32_bf16 v28, v114, v5, v28
    v_dot2_f32_bf16 v29, v114, v6, v29
    v_dot2_f32_bf16 v30, v115, v5, v30
    v_dot2_f32_bf16 v31, v115, v6, v31
    v_lshrrev_b32 v5, 16, v37
    v_and_b32 v6, 0xffff0000, v37
    s_waitcnt vmcnt(12)
    v_dot2_f32_bf16 v8, v116, v5, v8
    v_dot2_f32_bf16 v9, v116, v6, v9
    v_dot2_f32_bf16 v10, v117, v5, v10
    v_dot2_f32_bf16 v11, v117, v6, v11
    v_dot2_f32_bf16 v12, v118, v5, v12
    v_dot2_f32_bf16 v13, v118, v6, v13
    v_dot2_f32_bf16 v14, v119, v5, v14
    v_dot2_f32_bf16 v15, v119, v6, v15
    v_dot2_f32_bf16 v16, v120, v5, v16
    v_dot2_f32_bf16 v17, v120, v6, v17
    v_dot2_f32_bf16 v18, v121, v5, v18
    v_dot2_f32_bf16 v19, v121, v6, v19
    v_dot2_f32_bf16 v20, v122, v5, v20
    v_dot2_f32_bf16 v21, v122, v6, v21
    v_dot2_f32_bf16 v22, v123, v5, v22
    v_dot2_f32_bf16 v23, v123, v6, v23
    v_dot2_f32_bf16 v24, v124, v5, v24
    v_dot2_f32_bf16 v25, v124, v6, v25
    v_dot2_f32_bf16 v26, v125, v5, v26
    v_dot2_f32_bf16 v27, v125, v6, v27
    v_dot2_f32_bf16 v28, v126, v5, v28
    v_dot2_f32_bf16 v29, v126, v6, v29
    v_dot2_f32_bf16 v30, v127, v5, v30
    v_dot2_f32_bf16 v31, v127, v6, v31
    v_and_b32 v5, 0xffff, v38
    v_lshlrev_b32 v6, 16, v38
    s_waitcnt vmcnt(9)
    v_dot2_f32_bf16 v8, v44, v5, v8
    v_dot2_f32_bf16 v9, v44, v6, v9
    v_dot2_f32_bf16 v10, v45, v5, v10
    v_dot2_f32_bf16 v11, v45, v6, v11
    v_dot2_f32_bf16 v12, v46, v5, v12
    v_dot2_f32_bf16 v13, v46, v6, v13
    v_dot2_f32_bf16 v14, v47, v5, v14
    v_dot2_f32_bf16 v15, v47, v6, v15
    v_dot2_f32_bf16 v16, v48, v5, v16
    v_dot2_f32_bf16 v17, v48, v6, v17
    v_dot2_f32_bf16 v18, v49, v5, v18
    v_dot2_f32_bf16 v19, v49, v6, v19
    v_dot2_f32_bf16 v20, v50, v5, v20
    v_dot2_f32_bf16 v21, v50, v6, v21
    v_dot2_f32_bf16 v22, v51, v5, v22
    v_dot2_f32_bf16 v23, v51, v6, v23
    v_dot2_f32_bf16 v24, v52, v5, v24
    v_dot2_f32_bf16 v25, v52, v6, v25
    v_dot2_f32_bf16 v26, v53, v5, v26
    v_dot2_f32_bf16 v27, v53, v6, v27
    v_dot2_f32_bf16 v28, v54, v5, v28
    v_dot2_f32_bf16 v29, v54, v6, v29
    v_dot2_f32_bf16 v30, v55, v5, v30
    v_dot2_f32_bf16 v31, v55, v6, v31
    v_lshrrev_b32 v5, 16, v38
    v_and_b32 v6, 0xffff0000, v38
    s_waitcnt vmcnt(6)
    v_dot2_f32_bf16 v8, v56, v5, v8
    v_dot2_f32_bf16 v9, v56, v6, v9
    v_dot2_f32_bf16 v10, v57, v5, v10
    v_dot2_f32_bf16 v11, v57, v6, v11
    v_dot2_f32_bf16 v12, v58, v5, v12
    v_dot2_f32_bf16 v13, v58, v6, v13
    v_dot2_f32_bf16 v14, v59, v5, v14
    v_dot2_f32_bf16 v15, v59, v6, v15
    v_dot2_f32_bf16 v16, v60, v5, v16
    v_dot2_f32_bf16 v17, v60, v6, v17
    v_dot2_f32_bf16 v18, v61, v5, v18
    v_dot2_f32_bf16 v19, v61, v6, v19
    v_dot2_f32_bf16 v20, v62, v5, v20
    v_dot2_f32_bf16 v21, v62, v6, v21
    v_dot2_f32_bf16 v22, v63, v5, v22
    v_dot2_f32_bf16 v23, v63, v6, v23
    v_dot2_f32_bf16 v24, v64, v5, v24
    v_dot2_f32_bf16 v25, v64, v6, v25
    v_dot2_f32_bf16 v26, v65, v5, v26
    v_dot2_f32_bf16 v27, v65, v6, v27
    v_dot2_f32_bf16 v28, v66, v5, v28
    v_dot2_f32_bf16 v29, v66, v6, v29
    v_dot2_f32_bf16 v30, v67, v5, v30
    v_dot2_f32_bf16 v31, v67, v6, v31
    v_and_b32 v5, 0xffff, v39
    v_lshlrev_b32 v6, 16, v39
    s_waitcnt vmcnt(3)
    v_dot2_f32_bf16 v8, v68, v5, v8
    v_dot2_f32_bf16 v9, v68, v6, v9
    v_dot2_f32_bf16 v10, v69, v5, v10
    v_dot2_f32_bf16 v11, v69, v6, v11
    v_dot2_f32_bf16 v12, v70, v5, v12
    v_dot2_f32_bf16 v13, v70, v6, v13
    v_dot2_f32_bf16 v14, v71, v5, v14
    v_dot2_f32_bf16 v15, v71, v6, v15
    v_dot2_f32_bf16 v16, v72, v5, v16
    v_dot2_f32_bf16 v17, v72, v6, v17
    v_dot2_f32_bf16 v18, v73, v5, v18
    v_dot2_f32_bf16 v19, v73, v6, v19
    v_dot2_f32_bf16 v20, v74, v5, v20
    v_dot2_f32_bf16 v21, v74, v6, v21
    v_dot2_f32_bf16 v22, v75, v5, v22
    v_dot2_f32_bf16 v23, v75, v6, v23
    v_dot2_f32_bf16 v24, v76, v5, v24
    v_dot2_f32_bf16 v25, v76, v6, v25
    v_dot2_f32_bf16 v26, v77, v5, v26
    v_dot2_f32_bf16 v27, v77, v6, v27
    v_dot2_f32_bf16 v28, v78, v5, v28
    v_dot2_f32_bf16 v29, v78, v6, v29
    v_dot2_f32_bf16 v30, v79, v5, v30
    v_dot2_f32_bf16 v31, v79, v6, v31
    v_lshrrev_b32 v5, 16, v39
    v_and_b32 v6, 0xffff0000, v39
    s_waitcnt vmcnt(0)
    v_dot2_f32_bf16 v8, v80, v5, v8
    v_dot2_f32_bf16 v9, v80, v6, v9
    v_dot2_f32_bf16 v10, v81, v5, v10
    v_dot2_f32_bf16 v11, v81, v6, v11
    v_dot2_f32_bf16 v12, v82, v5, v12
    v_dot2_f32_bf16 v13, v82, v6, v13
    v_dot2_f32_bf16 v14, v83, v5, v14
    v_dot2_f32_bf16 v15, v83, v6, v15
    v_dot2_f32_bf16 v16, v84, v5, v16
    v_dot2_f32_bf16 v17, v84, v6, v17
    v_dot2_f32_bf16 v18, v85, v5, v18
    v_dot2_f32_bf16 v19, v85, v6, v19
    v_dot2_f32_bf16 v20, v86, v5, v20
    v_dot2_f32_bf16 v21, v86, v6, v21
    v_dot2_f32_bf16 v22, v87, v5, v22
    v_dot2_f32_bf16 v23, v87, v6, v23
    v_dot2_f32_bf16 v24, v88, v5, v24
    v_dot2_f32_bf16 v25, v88, v6, v25
    v_dot2_f32_bf16 v26, v89, v5, v26
    v_dot2_f32_bf16 v27, v89, v6, v27
    v_dot2_f32_bf16 v28, v90, v5, v28
    v_dot2_f32_bf16 v29, v90, v6, v29
    v_dot2_f32_bf16 v30, v91, v5, v30
    v_dot2_f32_bf16 v31, v91, v6, v31
    s_mul_i32 s12, s84, 11
    s_lshr_b32 s12, s12, 5
    s_mul_i32 s4, s12, 3
    s_sub_u32 s4, s84, s4
    s_lshl_b32 s4, s4, 10
    v_lshlrev_b32 v4, 4, v3
    buffer_load_dwordx4 v[116:119], v4, s[68:71], s4 offen
    buffer_load_dwordx4 v[120:123], v4, s[72:75], s4 offen
    buffer_load_dwordx4 v[124:127], v4, s[76:79], s4 offen
    v_mov_b32 v5, 0
    global_load_ushort v115, v5, s[34:35]
    v_permlane32_swap_b32 v8, v20
    v_permlane32_swap_b32 v9, v21
    v_permlane32_swap_b32 v10, v22
    v_permlane32_swap_b32 v11, v23
    v_permlane32_swap_b32 v12, v24
    v_permlane32_swap_b32 v13, v25
    v_permlane32_swap_b32 v14, v26
    v_permlane32_swap_b32 v15, v27
    v_permlane32_swap_b32 v16, v28
    v_permlane32_swap_b32 v17, v29
    v_permlane32_swap_b32 v18, v30
    v_permlane32_swap_b32 v19, v31
    s_nop 1
    v_add_f32 v8, v8, v20
    v_add_f32 v9, v9, v21
    v_add_f32 v10, v10, v22
    v_add_f32 v11, v11, v23
    v_add_f32 v12, v12, v24
    v_add_f32 v13, v13, v25
    v_add_f32 v14, v14, v26
    v_add_f32 v15, v15, v27
    v_add_f32 v16, v16, v28
    v_add_f32 v17, v17, v29
    v_add_f32 v18, v18, v30
    v_add_f32 v19, v19, v31
    s_nop 1
    v_permlane16_swap_b32 v8, v14
    v_permlane16_swap_b32 v9, v15
    v_permlane16_swap_b32 v10, v16
    v_permlane16_swap_b32 v11, v17
    v_permlane16_swap_b32 v12, v18
    v_permlane16_swap_b32 v13, v19
    s_nop 1
    v_add_f32 v8, v8, v14
    v_add_f32 v9, v9, v15
    v_add_f32 v10, v10, v16
    v_add_f32 v11, v11, v17
    v_add_f32 v12, v12, v18
    v_add_f32 v13, v13, v19
    s_nop 1
    v_add_f32_dpp v8, v8, v8 row_ror:8 row_mask:0xf bank_mask:0xf
    v_add_f32_dpp v9, v9, v9 row_ror:8 row_mask:0xf bank_mask:0xf
    v_add_f32_dpp v10, v10, v10 row_ror:8 row_mask:0xf bank_mask:0xf
    v_add_f32_dpp v11, v11, v11 row_ror:8 row_mask:0xf bank_mask:0xf
    v_add_f32_dpp v12, v12, v12 row_ror:8 row_mask:0xf bank_mask:0xf
    v_add_f32_dpp v13, v13, v13 row_ror:8 row_mask:0xf bank_mask:0xf
    v_and_b32 v4, 8, v3
    v_cmp_ne_u32 vcc, 0, v4
    v_lshrrev_b32 v4, 3, v3
    v_mul_u32_u24 v4, 3, v4
    v_cndmask_b32 v8, v8, v11, vcc
    v_cndmask_b32 v9, v9, v12, vcc
    v_cndmask_b32 v10, v10, v13, vcc
    v_and_b32 v5, 7, v3
    v_lshlrev_b32 v5, 5, v5
    s_mul_i32 s5, s84, 768
    v_add_u32 v5, s5, v5
    v_add_u32 v6, 0, v4
    v_lshrrev_b32 v7, 3, v6
    v_and_b32 v6, 7, v6
    v_lshl_add_u32 v6, v7, 6, v6
    v_lshl_add_u32 v6, v6, 2, v5
    ds_write_b32 v6, v8 offset:13568
    v_add_u32 v6, 1, v4
    v_lshrrev_b32 v7, 3, v6
    v_and_b32 v6, 7, v6
    v_lshl_add_u32 v6, v7, 6, v6
    v_lshl_add_u32 v6, v6, 2, v5
    ds_write_b32 v6, v9 offset:13568
    v_add_u32 v6, 2, v4
    v_lshrrev_b32 v7, 3, v6
    v_and_b32 v6, 7, v6
    v_lshl_add_u32 v6, v7, 6, v6
    v_lshl_add_u32 v6, v6, 2, v5
    ds_write_b32 v6, v10 offset:13568
    s_waitcnt lgkmcnt(0)
    s_barrier
    s_cmp_lt_u32 s84, 2
    s_cbranch_scc1 L_t_pub
    s_cmp_eq_u32 s84, 15
    s_cbranch_scc1 L_t_s5
    s_cmp_lt_u32 s99, 3
    s_cbranch_scc1 L_t_idle
    s_cmp_lt_u32 s84, 5
    s_cbranch_scc1 L_t_s3
    s_cmp_lt_u32 s84, 13
    s_cbranch_scc1 L_t_mfma
L_t_idle:
    s_barrier
    s_cmp_ge_u32 s2, 40
    s_cbranch_scc1 L_t_b7
    s_cmp_ge_u32 s99, 3
    s_cbranch_scc1 L_t_b7
    s_lshr_b32 s3, s2, 3
    s_lshl_b32 s3, s3, 2
    s_and_b32 s4, s2, 7
    s_lshr_b32 s4, s4, 1
    s_add_u32 s3, s3, s4
    s_cmp_lt_u32 s84, 10
    s_cbranch_scc1 L_t_s4
    s_branch L_t_b7
L_t_pub:
    v_cmp_gt_u32 vcc, 96, v0
    s_and_saveexec_b64 s[4:5], vcc
    v_lshlrev_b32 v4, 3, v0
    ds_read_b64 v[48:49], v4 offset:13568
    ds_read_b64 v[50:51], v4 offset:14336
    ds_read_b64 v[52:53], v4 offset:15104
    ds_read_b64 v[54:55], v4 offset:15872
    ds_read_b64 v[56:57], v4 offset:16640
    ds_read_b64 v[58:59], v4 offset:17408
    ds_read_b64 v[60:61], v4 offset:18176
    ds_read_b64 v[62:63], v4 offset:18944
    ds_read_b64 v[64:65], v4 offset:19712
    ds_read_b64 v[66:67], v4 offset:20480
    ds_read_b64 v[68:69], v4 offset:21248
    ds_read_b64 v[70:71], v4 offset:22016
    ds_read_b64 v[72:73], v4 offset:22784
    ds_read_b64 v[74:75], v4 offset:23552
    ds_read_b64 v[76:77], v4 offset:24320
    ds_read_b64 v[78:79], v4 offset:25088
    s_waitcnt lgkmcnt(0)
    v_pk_add_f32 v[48:49], v[48:49], v[64:65]
    v_pk_add_f32 v[50:51], v[50:51], v[66:67]
    v_pk_add_f32 v[52:53], v[52:53], v[68:69]
    v_pk_add_f32 v[54:55], v[54:55], v[70:71]
    v_pk_add_f32 v[56:57], v[56:57], v[72:73]
    v_pk_add_f32 v[58:59], v[58:59], v[74:75]
    v_pk_add_f32 v[60:61], v[60:61], v[76:77]
    v_pk_add_f32 v[62:63], v[62:63], v[78:79]
    v_pk_add_f32 v[48:49], v[48:49], v[56:57]
    v_pk_add_f32 v[50:51], v[50:51], v[58:59]
    v_pk_add_f32 v[52:53], v[52:53], v[60:61]
    v_pk_add_f32 v[54:55], v[54:55], v[62:63]
    v_pk_add_f32 v[48:49], v[48:49], v[52:53]
    v_pk_add_f32 v[50:51], v[50:51], v[54:55]
    v_pk_add_f32 v[48:49], v[48:49], v[50:51]
    v_mov_b32 v50, s42
    v_mov_b32 v51, s43
    s_lshl_b32 s6, s85, 3
    s_add_u32 s6, s6, s86
    s_mul_i32 s6, s6, 1536
    s_add_u32 s6, s6, 131072
    v_lshlrev_b32 v4, 4, v0
    buffer_store_dwordx4 v[48:51], v4, s[64:67], s6 offen sc1
    s_mov_b64 exec, s[4:5]
    s_barrier
    s_branch L_t_b7
L_t_s3:
    v_subrev_u32 v4, 128, v0
    v_cmp_le_u32 vcc, 96, v4
    v_mov_b32 v5, 0
    v_mov_b32 v6, 288
    v_cndmask_b32 v5, v5, v6, vcc
    v_add_u32 v5, v5, v4
    v_lshlrev_b32 v5, 4, v5
    s_mul_i32 s6, s13, 12288
    s_add_u32 s6, s6, 131072
    s_add_u32 s7, s6, 3072
    s_mov_b32 s92, 0
L_poll_13:
    buffer_load_dwordx4 v[100:103], v5, s[64:67], s6 offen sc1
    buffer_load_dwordx4 v[104:107], v5, s[64:67], s6 offen offset:1536 sc1
    buffer_load_dwordx4 v[108:111], v5, s[64:67], s7 offen sc1
    buffer_load_dwordx4 v[112:115], v5, s[64:67], s7 offen offset:1536 sc1
    s_waitcnt vmcnt(0)
    v_cmp_ne_u64 vcc, s[42:43], v[102:103]
    v_cmp_ne_u64 s[90:91], s[42:43], v[106:107]
    s_or_b64 vcc, vcc, s[90:91]
    v_cmp_ne_u64 s[90:91], s[42:43], v[110:111]
    s_or_b64 vcc, vcc, s[90:91]
    v_cmp_ne_u64 s[90:91], s[42:43], v[114:115]
    s_or_b64 vcc, vcc, s[90:91]
    s_cbranch_vccz L_pdone_14
    s_add_u32 s92, s92, 1
    s_cmp_lt_u32 s92, 65536
    s_cbranch_scc0 L_pdone_14
    s_branch L_poll_13
L_pdone_14:
    v_pk_add_f32 v[100:101], v[100:101], v[104:105]
    v_pk_add_f32 v[108:109], v[108:109], v[112:113]
    v_pk_add_f32 v[100:101], v[100:101], v[108:109]
    v_lshlrev_b32 v4, 2, v4
    v_cvt_pk_bf16_f32 v100, v100, v101
    ds_write_b32 v4, v100 offset:7552
    s_waitcnt lgkmcnt(0)
    s_barrier
    s_branch L_t_b7
L_t_mfma:
    v_lshrrev_b32 v4, 4, v3
    v_and_b32 v5, 15, v3
    v_lshrrev_b32 v6, 2, v5
    v_and_b32 v7, 3, v5
    v_lshl_add_u32 v6, v4, 3, v6
    v_lshlrev_b32 v6, 8, v6
    v_lshl_add_u32 v6, v7, 3, v6
    s_sub_u32 s4, s84, 5
    s_lshl_b32 s5, s4, 5
    s_add_u32 s5, s5, 25856
    v_add_u32 v6, s5, v6
    ds_read_b64_tr_b16 v[48:49], v6 offset:0
    ds_read_b64_tr_b16 v[50:51], v6 offset:1024
    ds_read_b64_tr_b16 v[52:53], v6 offset:8192
    ds_read_b64_tr_b16 v[54:55], v6 offset:9216
    ds_read_b64_tr_b16 v[56:57], v6 offset:16384
    ds_read_b64_tr_b16 v[58:59], v6 offset:17408
    ds_read_b64_tr_b16 v[60:61], v6 offset:24576
    ds_read_b64_tr_b16 v[62:63], v6 offset:25600
    ds_read_b64_tr_b16 v[64:65], v6 offset:32768
    ds_read_b64_tr_b16 v[66:67], v6 offset:33792
    ds_read_b64_tr_b16 v[68:69], v6 offset:40960
    ds_read_b64_tr_b16 v[70:71], v6 offset:41984
    v_and_b32 v7, 1, v3
    v_mul_u32_u24 v7, 384, v7
    v_lshl_add_u32 v7, v4, 4, v7
    v_mov_b32 v96, 0
    v_mov_b32 v97, 0
    v_mov_b32 v98, 0
    v_mov_b32 v99, 0
    s_mul_i32 s6, s13, 640
    s_lshl_b32 s7, s99, 7
    s_add_u32 s6, s6, s7
    s_sub_u32 s6, s6, 384
    s_lshl_b32 s7, s4, 4
    s_add_u32 s6, s6, s7
    s_lshl_b32 s6, s6, 4
    s_add_u32 s6, s6, 589824
    v_lshlrev_b32 v4, 4, v3
    s_waitcnt lgkmcnt(0)
    s_barrier
    ds_read_b128 v[72:75], v7 offset:7552
    ds_read_b128 v[76:79], v7 offset:7616
    ds_read_b128 v[80:83], v7 offset:7680
    ds_read_b128 v[84:87], v7 offset:7744
    ds_read_b128 v[88:91], v7 offset:7808
    ds_read_b128 v[92:95], v7 offset:7872
    s_waitcnt lgkmcnt(5)
    v_mfma_f32_16x16x32_bf16 v[96:99], v[72:75], v[48:51], v[96:99]
    s_waitcnt lgkmcnt(4)
    v_mfma_f32_16x16x32_bf16 v[96:99], v[76:79], v[52:55], v[96:99]
    s_waitcnt lgkmcnt(3)
    v_mfma_f32_16x16x32_bf16 v[96:99], v[80:83], v[56:59], v[96:99]
    s_waitcnt lgkmcnt(2)
    v_mfma_f32_16x16x32_bf16 v[96:99], v[84:87], v[60:63], v[96:99]
    s_waitcnt lgkmcnt(1)
    v_mfma_f32_16x16x32_bf16 v[96:99], v[88:91], v[64:67], v[96:99]
    s_waitcnt lgkmcnt(0)
    v_mfma_f32_16x16x32_bf16 v[96:99], v[92:95], v[68:71], v[96:99]
    s_nop 7
    v_mov_b32 v98, s42
    v_mov_b32 v99, s43
    s_mov_b32 exec_lo, 0xffff
    s_mov_b32 exec_hi, 0x0
    buffer_store_dwordx4 v[96:99], v4, s[64:67], s6 offen sc1
    s_mov_b64 exec, -1
    s_branch L_t_b7
L_t_s4:
    v_and_b32 v4, 31, v3
    v_lshrrev_b32 v5, 5, v3
    v_mul_u32_u24 v5, 640, v5
    v_add_u32 v5, v5, v4
    v_lshlrev_b32 v5, 4, v5
    s_sub_u32 s4, s84, 2
    s_mul_i32 s6, s4, 40960
    s_lshl_b32 s7, s3, 9
    s_add_u32 s6, s6, s7
    s_add_u32 s6, s6, 589824
    s_add_u32 s7, s6, 20480
    s_lshl_b32 s5, s3, 6
    v_lshlrev_b32 v6, 1, v4
    buffer_load_ushort v108, v6, s[44:47], s5 offen
    buffer_load_ushort v109, v6, s[44:47], s5 offen offset:1280
    s_mov_b32 s92, 0
    s_mov_b64 exec, -1
    s_mov_b64 s[8:9], exec
    s_mov_b64 exec, -1
    s_mov_b64 s[10:11], exec
L_pm_15:
    s_mov_b64 exec, s[8:9]
    buffer_load_dwordx4 v[100:103], v5, s[64:67], s6 offen sc1
    s_mov_b64 exec, s[10:11]
    buffer_load_dwordx4 v[104:107], v5, s[64:67], s7 offen sc1
    s_waitcnt vmcnt(0)
    s_mov_b64 exec, s[8:9]
    v_cmp_ne_u64 s[8:9], s[42:43], v[102:103]
    s_mov_b64 exec, s[10:11]
    v_cmp_ne_u64 s[10:11], s[42:43], v[106:107]
    s_mov_b64 vcc, s[8:9]
    s_or_b64 vcc, vcc, s[10:11]
    s_cmp_eq_u64 vcc, 0
    s_cbranch_scc1 L_pmd_16
    s_add_u32 s92, s92, 1
    s_cmp_lt_u32 s92, 65536
    s_cbranch_scc0 L_pmd_16
    s_branch L_pm_15
L_pmd_16:
    s_mov_b64 exec, -1
    v_pk_add_f32 v[100:101], v[100:101], v[104:105]
    s_lshl_b32 s4, s4, 8
    v_lshlrev_b32 v6, 3, v4
    v_add_u32 v6, s4, v6
    v_mov_b32 v102, v100
    v_mov_b32 v103, v101
    s_nop 1
    v_permlane32_swap_b32 v100, v102
    v_permlane32_swap_b32 v101, v103
    s_nop 0
    v_pk_add_f32 v[100:101], v[100:101], v[102:103]
    s_mov_b32 exec_lo, 0xffffffff
    s_mov_b32 exec_hi, 0x0
    ds_write_b64 v6, v[100:101] offset:2560
    s_mov_b64 exec, -1
    v_mov_b32 v6, 52
    v_mov_b32 v7, 1
    s_waitcnt lgkmcnt(0)
    s_mov_b32 exec_lo, 0x1
    s_mov_b32 exec_hi, 0x0
    ds_add_rtn_u32 v7, v6, v7 offset:7168
    s_waitcnt lgkmcnt(0)
    v_readfirstlane_b32 s5, v7
    s_mov_b64 exec, -1
    s_cmp_lg_u32 s5, 7
    s_cbranch_scc1 L_t_b7
    v_lshlrev_b32 v6, 3, v4
    ds_read_b64 v[48:49], v6 offset:2560
    ds_read_b64 v[50:51], v6 offset:2816
    ds_read_b64 v[52:53], v6 offset:3072
    ds_read_b64 v[54:55], v6 offset:3328
    ds_read_b64 v[56:57], v6 offset:3584
    ds_read_b64 v[58:59], v6 offset:3840
    ds_read_b64 v[60:61], v6 offset:4096
    ds_read_b64 v[62:63], v6 offset:4352
    s_waitcnt lgkmcnt(0)
    v_pk_add_f32 v[48:49], v[48:49], v[56:57]
    v_pk_add_f32 v[50:51], v[50:51], v[58:59]
    v_pk_add_f32 v[52:53], v[52:53], v[60:61]
    v_pk_add_f32 v[54:55], v[54:55], v[62:63]
    v_pk_add_f32 v[48:49], v[48:49], v[52:53]
    v_pk_add_f32 v[50:51], v[50:51], v[54:55]
    v_pk_add_f32 v[48:49], v[48:49], v[50:51]
    v_cvt_pk_bf16_f32 v50, v48, v49
    v_lshlrev_b32 v48, 16, v50
    v_and_b32 v49, 0xffff0000, v50
    v_lshlrev_b32 v108, 16, v108
    v_lshlrev_b32 v109, 16, v109
    v_add_f32 v48, v48, v108
    v_add_f32 v49, v49, v109
    v_cmp_le_u32 vcc, 32, v3
    v_lshrrev_b32 v6, 5, v3
    v_mul_u32_u24 v6, 2560, v6
    v_cndmask_b32 v48, v48, v49, vcc
    v_lshl_add_u32 v6, v4, 2, v6
    s_nop 0
    v_mov_b32_dpp v49, v48 quad_perm:[1,1,3,3] row_mask:0xf bank_mask:0xf
    v_cvt_pk_bf16_f32 v104, v48, v49
    s_lshl_b32 s6, s3, 7
    s_add_u32 s6, s6, 983040
    v_mov_b32_dpp v105, v104 quad_perm:[2,2,2,2] row_mask:0xf bank_mask:0xf
    v_mov_b32 v106, s42
    v_mov_b32 v107, s43
    s_mov_b32 exec_lo, 0x11111111
    s_mov_b32 exec_hi, 0x11111111
    buffer_store_dwordx4 v[104:107], v6, s[64:67], s6 offen sc1
    s_mov_b64 exec, -1
    s_branch L_t_b7
L_t_s5:
    s_barrier
    s_lshr_b32 s4, s2, 7
    s_mul_i32 s6, s4, 2560
    s_add_u32 s6, s6, 983040
    v_lshlrev_b32 v5, 4, v3
    v_mov_b32 v108, 0
    v_mov_b32 v109, 0
    v_mov_b32 v64, 0
    v_mov_b32 v65, 0
    v_lshlrev_b32 v4, 3, v3
    s_mov_b32 s4, 0x3f803f80
    s_mov_b32 s5, 0x3f80
    s_mov_b32 s7, 0x3f800000
    s_mov_b32 s92, 0
    s_mov_b64 exec, -1
    s_mov_b64 s[8:9], exec
    s_mov_b64 exec, -1
    s_mov_b64 s[10:11], exec
    s_mov_b32 exec_lo, 0xffffffff
    s_mov_b32 exec_hi, 0x0
    s_mov_b64 s[14:15], exec
L_pm_17:
    s_mov_b64 exec, s[8:9]
    buffer_load_dwordx4 v[100:103], v5, s[64:67], s6 offen sc1
    s_mov_b64 exec, s[10:11]
    buffer_load_dwordx4 v[104:107], v5, s[64:67], s6 offen offset:1024 sc1
    s_mov_b64 exec, s[14:15]
    buffer_load_dwordx4 v[108:111], v5, s[64:67], s6 offen offset:2048 sc1
    s_waitcnt vmcnt(0)
    s_mov_b64 exec, s[8:9]
    v_cmp_ne_u64 s[8:9], s[42:43], v[102:103]
    s_mov_b64 exec, s[10:11]
    v_cmp_ne_u64 s[10:11], s[42:43], v[106:107]
    s_mov_b64 exec, s[14:15]
    v_cmp_ne_u64 s[14:15], s[42:43], v[110:111]
    s_mov_b64 vcc, s[8:9]
    s_or_b64 vcc, vcc, s[10:11]
    s_or_b64 vcc, vcc, s[14:15]
    s_cmp_eq_u64 vcc, 0
    s_cbranch_scc1 L_pmd_18
    s_add_u32 s92, s92, 1
    s_cmp_lt_u32 s92, 65536
    s_cbranch_scc0 L_pmd_18
    s_branch L_pm_17
L_pmd_18:
    s_mov_b64 exec, -1
    v_dot2_f32_bf16 v66, v100, s4, 0
    v_dot2_f32_bf16 v68, v100, v100, 0
    v_dot2_f32_bf16 v66, v101, s4, v66
    v_dot2_f32_bf16 v68, v101, v101, v68
    v_dot2_f32_bf16 v66, v104, s4, v66
    v_dot2_f32_bf16 v68, v104, v104, v68
    v_dot2_f32_bf16 v66, v105, s4, v66
    v_dot2_f32_bf16 v68, v105, v105, v68
    v_dot2_f32_bf16 v66, v108, s4, v66
    v_dot2_f32_bf16 v68, v108, v108, v68
    v_dot2_f32_bf16 v66, v109, s4, v66
    v_dot2_f32_bf16 v68, v109, v109, v68
    s_nop 1
    s_nop 1
    v_add_f32_dpp v66, v66, v66 quad_perm:[1,0,3,2] row_mask:0xf bank_mask:0xf
    v_add_f32_dpp v68, v68, v68 quad_perm:[1,0,3,2] row_mask:0xf bank_mask:0xf
    s_nop 1
    v_add_f32_dpp v66, v66, v66 quad_perm:[2,3,0,1] row_mask:0xf bank_mask:0xf
    v_add_f32_dpp v68, v68, v68 quad_perm:[2,3,0,1] row_mask:0xf bank_mask:0xf
    s_nop 1
    v_add_f32_dpp v66, v66, v66 row_half_mirror row_mask:0xf bank_mask:0xf
    v_add_f32_dpp v68, v68, v68 row_half_mirror row_mask:0xf bank_mask:0xf
    s_nop 1
    v_add_f32_dpp v66, v66, v66 row_mirror row_mask:0xf bank_mask:0xf
    v_add_f32_dpp v68, v68, v68 row_mirror row_mask:0xf bank_mask:0xf
    v_mov_b32 v70, v66
    v_mov_b32 v71, v68
    s_nop 1
    v_permlane16_swap_b32 v66, v70
    v_permlane16_swap_b32 v68, v71
    s_nop 0
    v_add_f32 v66, v66, v70
    v_add_f32 v68, v68, v71
    v_mov_b32 v70, v66
    v_mov_b32 v71, v68
    s_nop 1
    v_permlane32_swap_b32 v66, v70
    v_permlane32_swap_b32 v68, v71
    s_nop 0
    v_add_f32 v66, v66, v70
    v_add_f32 v68, v68, v71
    v_mul_f32 v66, 0x3acccccd, v66
    v_mul_f32 v68, 0x3acccccd, v68
    v_fma_f32 v68, -v66, v66, v68
    v_max_f32 v68, 0, v68
    v_cvt_pk_bf16_f32 v70, v68, v66
    v_lshlrev_b32 v68, 16, v70
    v_and_b32 v66, 0xffff0000, v70
    v_add_f32 v68, 0x3727c5ac, v68
    v_cvt_pk_bf16_f32 v70, v68, v68
    v_lshlrev_b32 v68, 16, v70
    v_sqrt_f32 v68, v68
    v_sub_f32 v71, 0, v66
    v_cvt_pk_bf16_f32 v70, v68, v68
    v_lshlrev_b32 v68, 16, v70
    v_rcp_f32 v67, v68
    v_dot2_f32_bf16 v48, v100, s5, v71
    v_dot2_f32_bf16 v49, v100, s7, v71
    v_dot2_f32_bf16 v50, v101, s5, v71
    v_dot2_f32_bf16 v51, v101, s7, v71
    v_dot2_f32_bf16 v52, v104, s5, v71
    v_dot2_f32_bf16 v53, v104, s7, v71
    v_dot2_f32_bf16 v54, v105, s5, v71
    v_dot2_f32_bf16 v55, v105, s7, v71
    v_dot2_f32_bf16 v56, v108, s5, v71
    v_dot2_f32_bf16 v57, v108, s7, v71
    v_dot2_f32_bf16 v58, v109, s5, v71
    v_dot2_f32_bf16 v59, v109, s7, v71
    ds_write_b64 v4, v[100:101] offset:11008
    ds_write_b64 v4, v[104:105] offset:11520
    ds_write_b64 v4, v[108:109] offset:12032
    v_cvt_pk_bf16_f32 v72, v48, v49
    v_cvt_pk_bf16_f32 v73, v50, v51
    v_cvt_pk_bf16_f32 v74, v52, v53
    v_cvt_pk_bf16_f32 v75, v54, v55
    v_cvt_pk_bf16_f32 v76, v56, v57
    v_cvt_pk_bf16_f32 v77, v58, v59
    v_lshlrev_b32 v48, 16, v72
    v_and_b32 v49, 0xffff0000, v72
    v_lshlrev_b32 v50, 16, v73
    v_and_b32 v51, 0xffff0000, v73
    v_lshlrev_b32 v52, 16, v74
    v_and_b32 v53, 0xffff0000, v74
    v_lshlrev_b32 v54, 16, v75
    v_and_b32 v55, 0xffff0000, v75
    v_lshlrev_b32 v56, 16, v76
    v_and_b32 v57, 0xffff0000, v76
    v_lshlrev_b32 v58, 16, v77
    v_and_b32 v59, 0xffff0000, v77
    v_mul_f32 v48, v48, v67
    v_mul_f32 v49, v49, v67
    v_mul_f32 v50, v50, v67
    v_mul_f32 v51, v51, v67
    v_mul_f32 v52, v52, v67
    v_mul_f32 v53, v53, v67
    v_mul_f32 v54, v54, v67
    v_mul_f32 v55, v55, v67
    v_mul_f32 v56, v56, v67
    v_mul_f32 v57, v57, v67
    v_mul_f32 v58, v58, v67
    v_mul_f32 v59, v59, v67
    v_cvt_pk_bf16_f32 v60, v48, v49
    v_cvt_pk_bf16_f32 v61, v50, v51
    v_cvt_pk_bf16_f32 v62, v52, v53
    v_cvt_pk_bf16_f32 v63, v54, v55
    s_mov_b32 exec_lo, 0xffffffff
    s_mov_b32 exec_hi, 0x0
    v_cvt_pk_bf16_f32 v64, v56, v57
    v_cvt_pk_bf16_f32 v65, v58, v59
    s_mov_b64 exec, -1
    ds_write_b64 v4, v[60:61] offset:8448
    ds_write_b64 v4, v[62:63] offset:8960
    ds_write_b64 v4, v[64:65] offset:9472
    v_dot2_f32_bf16 v66, v60, s4, 0
    v_dot2_f32_bf16 v68, v60, v60, 0
    v_dot2_f32_bf16 v66, v61, s4, v66
    v_dot2_f32_bf16 v68, v61, v61, v68
    v_dot2_f32_bf16 v66, v62, s4, v66
    v_dot2_f32_bf16 v68, v62, v62, v68
    v_dot2_f32_bf16 v66, v63, s4, v66
    v_dot2_f32_bf16 v68, v63, v63, v68
    v_dot2_f32_bf16 v66, v64, s4, v66
    v_dot2_f32_bf16 v68, v64, v64, v68
    v_dot2_f32_bf16 v66, v65, s4, v66
    v_dot2_f32_bf16 v68, v65, v65, v68
    s_nop 1
    s_nop 1
    v_add_f32_dpp v66, v66, v66 quad_perm:[1,0,3,2] row_mask:0xf bank_mask:0xf
    v_add_f32_dpp v68, v68, v68 quad_perm:[1,0,3,2] row_mask:0xf bank_mask:0xf
    s_nop 1
    v_add_f32_dpp v66, v66, v66 quad_perm:[2,3,0,1] row_mask:0xf bank_mask:0xf
    v_add_f32_dpp v68, v68, v68 quad_perm:[2,3,0,1] row_mask:0xf bank_mask:0xf
    s_nop 1
    v_add_f32_dpp v66, v66, v66 row_half_mirror row_mask:0xf bank_mask:0xf
    v_add_f32_dpp v68, v68, v68 row_half_mirror row_mask:0xf bank_mask:0xf
    s_nop 1
    v_add_f32_dpp v66, v66, v66 row_mirror row_mask:0xf bank_mask:0xf
    v_add_f32_dpp v68, v68, v68 row_mirror row_mask:0xf bank_mask:0xf
    v_mov_b32 v70, v66
    v_mov_b32 v71, v68
    s_nop 1
    v_permlane16_swap_b32 v66, v70
    v_permlane16_swap_b32 v68, v71
    s_nop 0
    v_add_f32 v66, v66, v70
    v_add_f32 v68, v68, v71
    v_mov_b32 v70, v66
    v_mov_b32 v71, v68
    s_nop 1
    v_permlane32_swap_b32 v66, v70
    v_permlane32_swap_b32 v68, v71
    s_nop 0
    v_add_f32 v66, v66, v70
    v_add_f32 v68, v68, v71
    v_mul_f32 v66, 0x3acccccd, v66
    v_mul_f32 v68, 0x3acccccd, v68
    v_fma_f32 v68, -v66, v66, v68
    v_max_f32 v68, 0, v68
    v_cvt_pk_bf16_f32 v70, v68, v66
    v_lshlrev_b32 v68, 16, v70
    v_and_b32 v66, 0xffff0000, v70
    v_add_f32 v68, 0x3727c5ac, v68
    v_cvt_pk_bf16_f32 v70, v68, v68
    v_lshlrev_b32 v68, 16, v70
    v_sqrt_f32 v68, v68
    v_sub_f32 v71, 0, v66
    v_cvt_pk_bf16_f32 v70, v68, v68
    v_lshlrev_b32 v68, 16, v70
    v_rcp_f32 v67, v68
    v_mov_b32 v6, 0
    s_mov_b32 exec_lo, 0x1
    s_mov_b32 exec_hi, 0x0
    ds_write_b64 v6, v[66:67] offset:7312
    s_mov_b64 exec, -1
    s_waitcnt lgkmcnt(0)
    s_barrier
    s_branch L_t_b8
L_t_b7:
    s_waitcnt vmcnt(0)
    v_lshlrev_b32 v48, 16, v116
    v_and_b32 v49, 0xffff0000, v116
    v_lshlrev_b32 v56, 16, v120
    v_and_b32 v57, 0xffff0000, v120
    v_lshlrev_b32 v50, 16, v117
    v_and_b32 v51, 0xffff0000, v117
    v_lshlrev_b32 v58, 16, v121
    v_and_b32 v59, 0xffff0000, v121
    v_lshlrev_b32 v52, 16, v118
    v_and_b32 v53, 0xffff0000, v118
    v_lshlrev_b32 v60, 16, v122
    v_and_b32 v61, 0xffff0000, v122
    v_lshlrev_b32 v54, 16, v119
    v_and_b32 v55, 0xffff0000, v119
    v_lshlrev_b32 v62, 16, v123
    v_and_b32 v63, 0xffff0000, v123
    s_and_b32 s4, s2, 127
    s_mul_i32 s4, s4, 10
    v_mov_b32 v4, s4
    s_lshl_b32 s5, s12, 1
    v_add_u32 v5, s5, v4
    v_mov_b32 v6, 0
    s_mov_b32 s6, 0x3f80
    s_mov_b32 s7, 0x3f800000
    v_mov_b32 v64, 0xc0135761
    v_mov_b32 v65, 0xc0135761
    v_mov_b32 v66, 0xbdd2d3e8
    v_mov_b32 v67, 0xbdd2d3e8
    v_mov_b32 v68, 1.0
    v_mov_b32 v69, 1.0
    s_barrier
    ds_read_u16 v70, v5 offset:8448
    ds_read_b64 v[72:73], v6 offset:7312
    s_waitcnt lgkmcnt(0)
    v_lshlrev_b32 v70, 16, v70
    v_sub_f32 v70, v70, v72
    v_cvt_pk_bf16_f32 v71, v70, v70
    v_lshlrev_b32 v70, 16, v71
    v_mul_f32 v70, v70, v73
    v_cvt_pk_bf16_f32 v71, v70, v70
    v_lshlrev_b32 v70, 16, v71
    v_pk_mul_f32 v[76:77], v[48:49], v[70:71] op_sel_hi:[1,0]
    v_pk_mul_f32 v[78:79], v[50:51], v[70:71] op_sel_hi:[1,0]
    v_pk_mul_f32 v[80:81], v[52:53], v[70:71] op_sel_hi:[1,0]
    v_pk_mul_f32 v[82:83], v[54:55], v[70:71] op_sel_hi:[1,0]
    v_cvt_pk_bf16_f32 v92, v76, v77
    v_cvt_pk_bf16_f32 v93, v78, v79
    v_cvt_pk_bf16_f32 v94, v80, v81
    v_cvt_pk_bf16_f32 v95, v82, v83
    v_dot2_f32_bf16 v76, v92, s6, v56
    v_dot2_f32_bf16 v77, v92, s7, v57
    v_dot2_f32_bf16 v78, v93, s6, v58
    v_dot2_f32_bf16 v79, v93, s7, v59
    v_dot2_f32_bf16 v80, v94, s6, v60
    v_dot2_f32_bf16 v81, v94, s7, v61
    v_dot2_f32_bf16 v82, v95, s6, v62
    v_dot2_f32_bf16 v83, v95, s7, v63
    v_cvt_pk_bf16_f32 v92, v76, v77
    v_cvt_pk_bf16_f32 v93, v78, v79
    v_cvt_pk_bf16_f32 v94, v80, v81
    v_cvt_pk_bf16_f32 v95, v82, v83
    v_lshlrev_b32 v76, 16, v92
    v_and_b32 v77, 0xffff0000, v92
    v_lshlrev_b32 v78, 16, v93
    v_and_b32 v79, 0xffff0000, v93
    v_lshlrev_b32 v80, 16, v94
    v_and_b32 v81, 0xffff0000, v94
    v_lshlrev_b32 v82, 16, v95
    v_and_b32 v83, 0xffff0000, v95
    v_pk_mul_f32 v[84:85], v[76:77], v[76:77]
    v_pk_mul_f32 v[86:87], v[78:79], v[78:79]
    v_pk_mul_f32 v[88:89], v[80:81], v[80:81]
    v_pk_mul_f32 v[90:91], v[82:83], v[82:83]
    v_pk_fma_f32 v[84:85], v[84:85], v[66:67], v[64:65]
    v_pk_fma_f32 v[86:87], v[86:87], v[66:67], v[64:65]
    v_pk_fma_f32 v[88:89], v[88:89], v[66:67], v[64:65]
    v_pk_fma_f32 v[90:91], v[90:91], v[66:67], v[64:65]
    v_pk_mul_f32 v[84:85], v[84:85], v[76:77]
    v_pk_mul_f32 v[86:87], v[86:87], v[78:79]
    v_pk_mul_f32 v[88:89], v[88:89], v[80:81]
    v_pk_mul_f32 v[90:91], v[90:91], v[82:83]
    v_exp_f32 v84, v84
    v_exp_f32 v85, v85
    v_exp_f32 v86, v86
    v_exp_f32 v87, v87
    v_exp_f32 v88, v88
    v_exp_f32 v89, v89
    v_exp_f32 v90, v90
    v_exp_f32 v91, v91
    v_pk_add_f32 v[84:85], v[84:85], v[68:69]
    v_pk_add_f32 v[86:87], v[86:87], v[68:69]
    v_pk_add_f32 v[88:89], v[88:89], v[68:69]
    v_pk_add_f32 v[90:91], v[90:91], v[68:69]
    v_rcp_f32 v84, v84
    v_rcp_f32 v85, v85
    v_rcp_f32 v86, v86
    v_rcp_f32 v87, v87
    v_rcp_f32 v88, v88
    v_rcp_f32 v89, v89
    v_rcp_f32 v90, v90
    v_rcp_f32 v91, v91
    v_pk_mul_f32 v[84:85], v[84:85], v[76:77]
    v_pk_mul_f32 v[86:87], v[86:87], v[78:79]
    v_pk_mul_f32 v[88:89], v[88:89], v[80:81]
    v_pk_mul_f32 v[90:91], v[90:91], v[82:83]
    v_cvt_pk_bf16_f32 v92, v84, v85
    v_cvt_pk_bf16_f32 v93, v86, v87
    v_cvt_pk_bf16_f32 v94, v88, v89
    v_cvt_pk_bf16_f32 v95, v90, v91
    v_dot2_f32_bf16 v96, v92, v124, 0
    v_dot2_f32_bf16 v96, v93, v125, v96
    v_dot2_f32_bf16 v96, v94, v126, v96
    v_dot2_f32_bf16 v96, v95, v127, v96
    s_nop 2
    s_nop 1
    v_add_f32_dpp v96, v96, v96 quad_perm:[1,0,3,2] row_mask:0xf bank_mask:0xf
    s_nop 1
    v_add_f32_dpp v96, v96, v96 quad_perm:[2,3,0,1] row_mask:0xf bank_mask:0xf
    s_nop 1
    v_add_f32_dpp v96, v96, v96 row_half_mirror row_mask:0xf bank_mask:0xf
    s_nop 1
    v_add_f32_dpp v96, v96, v96 row_mirror row_mask:0xf bank_mask:0xf
    v_mov_b32 v97, v96
    s_nop 1
    v_permlane16_swap_b32 v96, v97
    s_nop 0
    v_add_f32 v96, v96, v97
    v_mov_b32 v97, v96
    s_nop 1
    v_permlane32_swap_b32 v96, v97
    s_nop 0
    v_add_f32 v96, v96, v97
    s_lshl_b32 s5, s84, 2
    v_mov_b32 v5, s5
    s_mov_b32 exec_lo, 0x1
    s_mov_b32 exec_hi, 0x0
    ds_write_b32 v5, v96 offset:8320
    s_mov_b64 exec, -1
    s_waitcnt lgkmcnt(0)
L_t_b8:
    s_barrier
    s_cmp_lg_u32 s84, 0
    s_cbranch_scc1 L_end
L_t_fin:
    v_lshlrev_b32 v5, 1, v3
    s_mov_b32 exec_lo, 0x1f
    s_mov_b32 exec_hi, 0x0
    v_mul_u32_u24 v7, 12, v3
    ds_read_b32 v48, v7 offset:8320
    ds_read_b32 v49, v7 offset:8324
    ds_read_b32 v50, v7 offset:8328
    v_add_u32 v6, v4, v5
    ds_read_u16 v60, v6 offset:11008
    s_mul_i32 s4, s2, 10
    v_lshlrev_b32 v51, 16, v115
    s_waitcnt lgkmcnt(0)
    v_add_f32 v48, v48, v49
    v_lshlrev_b32 v60, 16, v60
    v_add_f32 v48, v48, v50
    v_cvt_pk_bf16_f32 v49, v48, v48
    v_lshlrev_b32 v48, 16, v49
    v_add_f32 v48, v51, v48
    v_cvt_pk_bf16_f32 v49, v48, v48
    v_lshlrev_b32 v48, 16, v49
    v_add_f32 v48, v48, v60
    v_cvt_pk_bf16_f32 v48, v48, v48
    buffer_store_short v48, v5, s[80:83], s4 offen
    s_cmp_lg_u32 s2, 0
    s_cbranch_scc1 L_end
    s_mov_b64 exec, 1
    v_mov_b32 v48, s42
    v_mov_b32 v49, s43
    v_mov_b32 v5, 0
    buffer_store_dwordx2 v[48:49], v5, s[64:67], 0 offen sc1
L_end:
    s_endpgm

.section .rodata,"a"
.p2align 6
.amdhsa_kernel sequential_preLN__gqa_block_cached__mixer_token_mlp__decode_kernel
  .amdhsa_next_free_vgpr 128
  .amdhsa_next_free_sgpr 102
  .amdhsa_accum_offset 128
  .amdhsa_group_segment_fixed_size 0
  .amdhsa_kernarg_size 104
  .amdhsa_user_sgpr_count 2
  .amdhsa_user_sgpr_kernarg_segment_ptr 1
  .amdhsa_system_sgpr_workgroup_id_x 1
.end_amdhsa_kernel
```
